```python
import torch

def _softmax(x, axis=-1):
    return torch.softmax(x, dim=axis)

def _gelu(x):
    return torch.nn.functional.gelu(x, approximate='tanh')

def _silu(x):
    return torch.nn.functional.silu(x)

def _sigmoid(x):
    return torch.sigmoid(x)

def _layernorm(x, axis=-1, eps=1e-05):
    m = x.mean(dim=axis, keepdim=True)
    v = x.var(dim=axis, keepdim=True, unbiased=False)
    return (x - m) / torch.sqrt(v + eps)

def _scatter_add(tgt, idx, src, axis=0):
    return tgt.clone().index_add_(axis, idx, src)

def _segment_sum(src, seg, n):
    out = torch.zeros((n,) + src.shape[1:], dtype=src.dtype)
    return out.index_add_(0, seg, src)

def _pad(x, pw):
    flat = tuple((v for pair in reversed(pw) for v in pair))
    return torch.nn.functional.pad(x, flat)
kernel_name = 'adaLN_cond__ssm_conv_s4__mixer_s_mlp__prompt'

def setup_inputs():

    _w = lambda a: (lambda t: t.to(torch.bfloat16) if t.is_floating_point() else t)(torch.as_tensor(a))

    def _A_setup():
        B, L, D, N = (1, 2048, 448, 256)
        A_re = -(lambda _x: torch.exp(torch.as_tensor(_x)))((lambda *s: torch.randn(*s, dtype=torch.bfloat16) * 3.2)(D, N))
        A_im = torch.pi * (lambda *s: torch.randn(*s, dtype=torch.bfloat16) * 0.1)(D, N)
        B_re = (lambda *s: torch.randn(*s, dtype=torch.bfloat16) * 0.2)(D, N)
        B_im = (lambda *s: torch.randn(*s, dtype=torch.bfloat16) * 0.2)(D, N)
        C_re = (lambda *s: torch.randn(*s, dtype=torch.bfloat16) * 0.2)(D, N)
        C_im = (lambda *s: torch.randn(*s, dtype=torch.bfloat16) * 0.2)(D, N)
        log_dt = (lambda *s: torch.randn(*s, dtype=torch.bfloat16) * 0.1)(D) * 0.5 - 4.0
        Dskip = (lambda *s: torch.randn(*s, dtype=torch.bfloat16) * 0.1)(D)
        return {'u': _w((lambda *s: torch.randn(*s, dtype=torch.bfloat16) * 0.05)(B, L, D)), 'A_re': _w(A_re), 'A_im': _w(A_im), 'B_re': _w(B_re), 'B_im': _w(B_im), 'C_re': _w(C_re), 'C_im': _w(C_im), 'log_dt': _w(log_dt), 'Dskip': _w(Dskip)}
    _A_in = _A_setup()

    def _B_setup():
        B, S, D, F = (1, 2048, 448, 1792)
        return {'x': _w((lambda *s: torch.randn(*s, dtype=torch.bfloat16) * 0.05)(B, S, D)), 'w1': _w((lambda *s: torch.randn(*s, dtype=torch.bfloat16) * 3.2)(D, D) * D ** (-0.5)), 'w2': _w((lambda *s: torch.randn(*s, dtype=torch.bfloat16) * 3.2)(D, D) * D ** (-0.5)), 'w3': _w((lambda *s: torch.randn(*s, dtype=torch.bfloat16) * 3.2)(D, F) * D ** (-0.5)), 'w4': _w((lambda *s: torch.randn(*s, dtype=torch.bfloat16) * 3.2)(F, D) * F ** (-0.5))}
    _B_in = _B_setup()
    return {'A_u': _A_in['u'], 'A_A_re': _A_in['A_re'], 'A_A_im': _A_in['A_im'], 'A_B_re': _A_in['B_re'], 'A_B_im': _A_in['B_im'], 'A_C_re': _A_in['C_re'], 'A_C_im': _A_in['C_im'], 'A_log_dt': _A_in['log_dt'], 'A_Dskip': _A_in['Dskip'], 'B_x': _B_in['x'], 'B_w1': _B_in['w1'], 'B_w2': _B_in['w2'], 'B_w3': _B_in['w3'], 'B_w4': _B_in['w4'], 'c': _w((lambda *s: torch.randn(*s, dtype=torch.bfloat16) * 0.1)(1, 448) * 8.0), 'w_mod': _w((lambda *s: torch.randn(*s, dtype=torch.bfloat16) * 0.1)(448, 6 * 448) * 448 ** (-0.5) * 8.0)}

def reference(A_u, A_A_re, A_A_im, A_B_re, A_B_im, A_C_re, A_C_im, A_log_dt, A_Dskip, B_x, B_w1, B_w2, B_w3, B_w4, c, w_mod):

    def _A_ref(u, A_re, A_im, B_re, B_im, C_re, C_im, log_dt, Dskip):
        Bsz, L, D = u.shape
        dt = torch.exp(log_dt)[:, None]
        A = A_re + 1j * A_im
        Bc = B_re + 1j * B_im
        Cc = C_re + 1j * C_im
        logdA = dt * A
        dB = dt * Bc
        l = (lambda x, dt: x.to(dt))(torch.arange(L), A_re.dtype)
        P = torch.exp(logdA[:, :, None] * l[None, None, :])
        K = torch.einsum('dn,dnl,dn->dl', Cc, P, dB).real
        L2 = 2 * L
        Kp = _pad(K, ((0, 0), (0, L)))
        up = (lambda x, *d: x.permute(*d))(u, 0, 2, 1)
        up = _pad(up, ((0, 0), (0, 0), (0, L)))
        Kf = (lambda x, axes=(-2, -1): torch.fft.rfft2(x.float(), dim=axes))(Kp[:, None, :], axes=(-2, -1))
        Uf = (lambda x, axes=(-2, -1): torch.fft.rfft2(x.float(), dim=axes))(up[:, :, None, :], axes=(-2, -1))
        Yf = Uf * Kf[None, :, :, :]
        y = (lambda x, s, axes=(-2, -1): torch.fft.irfft2(x, s=s, dim=axes).to(torch.bfloat16))(Yf, (1, L2), axes=(-2, -1))[:, :, 0, :L]
        y = (lambda x, *d: x.permute(*d))(y, 0, 2, 1) + u * Dskip[None, None, :]
        return y

    def _B_ref(x, w1, w2, w3, w4):
        B, S, D = x.shape
        h = _gelu(_layernorm(x, axis=-1) @ w1)
        c = D // 4
        g0 = _pad(h[:, :, 0 * c:1 * c], ((0, 0), (1, 0), (0, 0)))[:, :S, :]
        g1 = _pad(h[:, :, 1 * c:2 * c], ((0, 0), (0, 1), (0, 0)))[:, 1:, :]
        g2 = _pad(h[:, :, 2 * c:3 * c], ((0, 0), (2, 0), (0, 0)))[:, :S, :]
        g3 = _pad(h[:, :, 3 * c:], ((0, 0), (0, 2), (0, 0)))[:, 2:, :]
        hs = torch.concatenate([g0, g1, g2, g3], axis=-1) @ w2
        x1 = x + hs
        h2 = _gelu(_layernorm(x1, axis=-1) @ w3) @ w4
        return x1 + h2
    x = A_u
    mod = (_silu(c) @ w_mod).reshape(c.shape[0], 6, 1, -1)
    sa, ca, ga, sb, cb, gb = (mod[:, 0].clone(), mod[:, 1].clone(), mod[:, 2].clone(), mod[:, 3].clone(), mod[:, 4].clone(), mod[:, 5].clone())
    h = _layernorm(x, axis=-1) * (1 + ca) + sa
    x = x + ga * _A_ref(h, A_A_re, A_A_im, A_B_re, A_B_im, A_C_re, A_C_im, A_log_dt, A_Dskip)
    h = _layernorm(x, axis=-1) * (1 + cb) + sb
    x = x + gb * _B_ref(h, B_w1, B_w2, B_w3, B_w4)
    return x
```

```asm
; @launch kernel=prep_kernel grid=(512,1,1) block=(256,1,1) lds=70144
; @launch kernel=conv_kernel grid=(294,1,1) block=(256,1,1) lds=79104
; @launch kernel=ln_gemm1_kernel grid=(256,1,1) block=(704,1,1) lds=56064
; @launch kernel=gemm2_kernel grid=(256,1,1) block=(448,1,1) lds=34816
; @launch kernel=gemm3_kernel grid=(224,1,1) block=(512,1,1) lds=156672
; @launch kernel=gemm4_kernel grid=(224,1,1) block=(512,1,1) lds=163840
.amdgcn_target "amdgcn-amd-amdhsa--gfx950"
.text
.globl prep_kernel
.p2align 8
.type prep_kernel,@function
prep_kernel:
    s_cmp_ge_u32 s2, 512
    s_cbranch_scc1 K1_END
    s_add_u32 s2, s2, 64
    s_and_b32 s2, s2, 511
    s_cmp_lt_u32 s2, 64
    s_cbranch_scc1 K1_LN
    s_cmp_lt_u32 s2, 512
    s_cbranch_scc1 K1_KGEN
    s_endpgm
K1_LN:
    s_load_dwordx2 s[4:5], s[0:1], 0
    s_load_dwordx2 s[8:9], s[0:1], 144
    s_load_dwordx4 s[12:15], s[0:1], 112
    v_lshrrev_b32 v1, 3, v0
    v_and_b32 v2, 7, v0
    s_and_b32 s22, s2, 7
    s_lshl_b32 s22, s22, 3
    s_lshr_b32 s23, s2, 3
    s_add_u32 s22, s22, s23
    s_mul_i32 s6, s22, 28672
    v_mul_u32_u24 v3, 896, v1
    v_lshl_add_u32 v3, v2, 4, v3
    v_add_u32 v3, s6, v3
    v_lshlrev_b32 v10, 1, v0
    s_lshl_b32 s7, s2, 7
    v_mul_u32_u24 v11, 5376, v1
    v_lshl_add_u32 v11, v2, 4, v11
    v_add_u32 v11, s7, v11
    s_waitcnt lgkmcnt(0)
    global_load_dwordx4 v[16:19], v3, s[4:5] offset:0
    global_load_dwordx4 v[20:23], v3, s[4:5] offset:128
    global_load_dwordx4 v[24:27], v3, s[4:5] offset:256
    global_load_dwordx4 v[28:31], v3, s[4:5] offset:384
    global_load_dwordx4 v[32:35], v3, s[4:5] offset:512
    global_load_dwordx4 v[36:39], v3, s[4:5] offset:640
    global_load_dwordx4 v[40:43], v3, s[4:5] offset:768
    s_mov_b32 s16, s12
    s_mov_b32 s17, s13
    s_mov_b32 s18, 896
    s_mov_b32 s19, 0x00020000
    buffer_load_ushort v12, v10, s[16:19], 0 offen
    buffer_load_ushort v13, v10, s[16:19], 0 offen offset:512
    s_cmp_ge_u32 s2, 42
    s_cbranch_scc1 K1_NOW
    global_load_dwordx4 v[64:67], v11, s[14:15]
    v_add_u32 v11, 172032, v11
    global_load_dwordx4 v[68:71], v11, s[14:15]
    v_add_u32 v11, 172032, v11
    global_load_dwordx4 v[72:75], v11, s[14:15]
    v_add_u32 v11, 172032, v11
    global_load_dwordx4 v[76:79], v11, s[14:15]
    v_add_u32 v11, 172032, v11
    global_load_dwordx4 v[80:83], v11, s[14:15]
    v_add_u32 v11, 172032, v11
    global_load_dwordx4 v[84:87], v11, s[14:15]
    v_add_u32 v11, 172032, v11
    global_load_dwordx4 v[88:91], v11, s[14:15]
    v_add_u32 v11, 172032, v11
    global_load_dwordx4 v[92:95], v11, s[14:15]
    v_add_u32 v11, 172032, v11
    global_load_dwordx4 v[96:99], v11, s[14:15]
    v_add_u32 v11, 172032, v11
    global_load_dwordx4 v[100:103], v11, s[14:15]
    v_add_u32 v11, 172032, v11
    global_load_dwordx4 v[104:107], v11, s[14:15]
    v_add_u32 v11, 172032, v11
    global_load_dwordx4 v[108:111], v11, s[14:15]
    v_add_u32 v11, 172032, v11
    global_load_dwordx4 v[112:115], v11, s[14:15]
    v_add_u32 v11, 172032, v11
    global_load_dwordx4 v[116:119], v11, s[14:15]
    s_waitcnt vmcnt(14)
    s_branch K1_NOW2
K1_NOW:
    s_waitcnt vmcnt(0)
K1_NOW2:
    v_mov_b32 v9, 0x3f803f80
    v_dot2_f32_bf16 v44, v16, v9, 0
    v_dot2_f32_bf16 v45, v16, v16, 0
    v_dot2_f32_bf16 v44, v17, v9, v44
    v_dot2_f32_bf16 v45, v17, v17, v45
    v_dot2_f32_bf16 v44, v18, v9, v44
    v_dot2_f32_bf16 v45, v18, v18, v45
    v_dot2_f32_bf16 v44, v19, v9, v44
    v_dot2_f32_bf16 v45, v19, v19, v45
    v_dot2_f32_bf16 v44, v20, v9, v44
    v_dot2_f32_bf16 v45, v20, v20, v45
    v_dot2_f32_bf16 v44, v21, v9, v44
    v_dot2_f32_bf16 v45, v21, v21, v45
    v_dot2_f32_bf16 v44, v22, v9, v44
    v_dot2_f32_bf16 v45, v22, v22, v45
    v_dot2_f32_bf16 v44, v23, v9, v44
    v_dot2_f32_bf16 v45, v23, v23, v45
    v_dot2_f32_bf16 v44, v24, v9, v44
    v_dot2_f32_bf16 v45, v24, v24, v45
    v_dot2_f32_bf16 v44, v25, v9, v44
    v_dot2_f32_bf16 v45, v25, v25, v45
    v_dot2_f32_bf16 v44, v26, v9, v44
    v_dot2_f32_bf16 v45, v26, v26, v45
    v_dot2_f32_bf16 v44, v27, v9, v44
    v_dot2_f32_bf16 v45, v27, v27, v45
    v_dot2_f32_bf16 v44, v28, v9, v44
    v_dot2_f32_bf16 v45, v28, v28, v45
    v_dot2_f32_bf16 v44, v29, v9, v44
    v_dot2_f32_bf16 v45, v29, v29, v45
    v_dot2_f32_bf16 v44, v30, v9, v44
    v_dot2_f32_bf16 v45, v30, v30, v45
    v_dot2_f32_bf16 v44, v31, v9, v44
    v_dot2_f32_bf16 v45, v31, v31, v45
    v_dot2_f32_bf16 v44, v32, v9, v44
    v_dot2_f32_bf16 v45, v32, v32, v45
    v_dot2_f32_bf16 v44, v33, v9, v44
    v_dot2_f32_bf16 v45, v33, v33, v45
    v_dot2_f32_bf16 v44, v34, v9, v44
    v_dot2_f32_bf16 v45, v34, v34, v45
    v_dot2_f32_bf16 v44, v35, v9, v44
    v_dot2_f32_bf16 v45, v35, v35, v45
    v_dot2_f32_bf16 v44, v36, v9, v44
    v_dot2_f32_bf16 v45, v36, v36, v45
    v_dot2_f32_bf16 v44, v37, v9, v44
    v_dot2_f32_bf16 v45, v37, v37, v45
    v_dot2_f32_bf16 v44, v38, v9, v44
    v_dot2_f32_bf16 v45, v38, v38, v45
    v_dot2_f32_bf16 v44, v39, v9, v44
    v_dot2_f32_bf16 v45, v39, v39, v45
    v_dot2_f32_bf16 v44, v40, v9, v44
    v_dot2_f32_bf16 v45, v40, v40, v45
    v_dot2_f32_bf16 v44, v41, v9, v44
    v_dot2_f32_bf16 v45, v41, v41, v45
    v_dot2_f32_bf16 v44, v42, v9, v44
    v_dot2_f32_bf16 v45, v42, v42, v45
    v_dot2_f32_bf16 v44, v43, v9, v44
    v_dot2_f32_bf16 v45, v43, v43, v45
    v_lshlrev_b32 v12, 16, v12
    v_mul_f32 v14, 0xbfb8aa3b, v12
    v_exp_f32 v14, v14
    s_nop 0
    v_add_f32 v14, 1.0, v14
    v_rcp_f32 v14, v14
    s_nop 0
    v_mul_f32 v12, v12, v14
    v_cvt_pk_bf16_f32 v12, v12, v12
    v_lshlrev_b32 v12, 16, v12
    v_lshlrev_b32 v13, 16, v13
    v_mul_f32 v14, 0xbfb8aa3b, v13
    v_exp_f32 v14, v14
    s_nop 0
    v_add_f32 v14, 1.0, v14
    v_rcp_f32 v14, v14
    s_nop 0
    v_mul_f32 v13, v13, v14
    v_cvt_pk_bf16_f32 v13, v13, v13
    v_lshlrev_b32 v13, 16, v13
    v_lshlrev_b32 v10, 2, v0
    ds_write_b32 v10, v12 offset:30208
    ds_write_b32 v10, v13 offset:31232
    v_add_f32_dpp v44, v44, v44 quad_perm:[1,0,3,2] row_mask:0xf bank_mask:0xf
    v_add_f32_dpp v45, v45, v45 quad_perm:[1,0,3,2] row_mask:0xf bank_mask:0xf
    s_nop 0
    v_add_f32_dpp v44, v44, v44 quad_perm:[2,3,0,1] row_mask:0xf bank_mask:0xf
    v_add_f32_dpp v45, v45, v45 quad_perm:[2,3,0,1] row_mask:0xf bank_mask:0xf
    s_nop 0
    v_add_f32_dpp v44, v44, v44 row_half_mirror row_mask:0xf bank_mask:0xf
    v_add_f32_dpp v45, v45, v45 row_half_mirror row_mask:0xf bank_mask:0xf
    v_mul_f32 v44, 0x3b124925, v44
    v_mul_f32 v45, 0x3b124925, v45
    v_fma_f32 v45, -v44, v44, v45
    v_max_f32 v45, 0, v45
    v_cvt_pk_bf16_f32 v46, v44, v44
    v_lshlrev_b32 v46, 16, v46
    v_cvt_pk_bf16_f32 v47, v45, v45
    v_lshlrev_b32 v47, 16, v47
    v_add_f32 v47, 0x3727c5ac, v47
    v_cvt_pk_bf16_f32 v47, v47, v47
    v_lshlrev_b32 v47, 16, v47
    v_sqrt_f32 v47, v47
    s_nop 0
    v_cvt_pk_bf16_f32 v47, v47, v47
    v_lshlrev_b32 v47, 16, v47
    v_rcp_f32 v48, v47
    s_nop 0
    v_mov_b32 v49, v48
    v_mov_b32 v47, v46
    v_mul_u32_u24 v4, 928, v1
    v_lshrrev_b32 v5, 3, v1
    v_lshl_add_u32 v4, v5, 7, v4
    v_lshl_add_u32 v4, v2, 4, v4
    v_lshlrev_b32 v52, 16, v16
    v_and_b32 v53, 0xffff0000, v16
    v_pk_add_f32 v[52:53], v[52:53], v[46:47] neg_lo:[0,1] neg_hi:[0,1]
    v_lshlrev_b32 v54, 16, v17
    v_and_b32 v55, 0xffff0000, v17
    v_pk_add_f32 v[54:55], v[54:55], v[46:47] neg_lo:[0,1] neg_hi:[0,1]
    v_lshlrev_b32 v56, 16, v18
    v_and_b32 v57, 0xffff0000, v18
    v_pk_add_f32 v[56:57], v[56:57], v[46:47] neg_lo:[0,1] neg_hi:[0,1]
    v_lshlrev_b32 v58, 16, v19
    v_and_b32 v59, 0xffff0000, v19
    v_pk_add_f32 v[58:59], v[58:59], v[46:47] neg_lo:[0,1] neg_hi:[0,1]
    v_cvt_pk_bf16_f32 v16, v52, v53
    v_cvt_pk_bf16_f32 v17, v54, v55
    v_cvt_pk_bf16_f32 v18, v56, v57
    v_cvt_pk_bf16_f32 v19, v58, v59
    v_lshlrev_b32 v52, 16, v16
    v_and_b32 v53, 0xffff0000, v16
    v_pk_mul_f32 v[52:53], v[52:53], v[48:49]
    v_lshlrev_b32 v54, 16, v17
    v_and_b32 v55, 0xffff0000, v17
    v_pk_mul_f32 v[54:55], v[54:55], v[48:49]
    v_lshlrev_b32 v56, 16, v18
    v_and_b32 v57, 0xffff0000, v18
    v_pk_mul_f32 v[56:57], v[56:57], v[48:49]
    v_lshlrev_b32 v58, 16, v19
    v_and_b32 v59, 0xffff0000, v19
    v_pk_mul_f32 v[58:59], v[58:59], v[48:49]
    v_cvt_pk_bf16_f32 v16, v52, v53
    v_cvt_pk_bf16_f32 v17, v54, v55
    v_cvt_pk_bf16_f32 v18, v56, v57
    v_cvt_pk_bf16_f32 v19, v58, v59
    ds_write_b128 v4, v[16:19] offset:0
    v_lshlrev_b32 v52, 16, v20
    v_and_b32 v53, 0xffff0000, v20
    v_pk_add_f32 v[52:53], v[52:53], v[46:47] neg_lo:[0,1] neg_hi:[0,1]
    v_lshlrev_b32 v54, 16, v21
    v_and_b32 v55, 0xffff0000, v21
    v_pk_add_f32 v[54:55], v[54:55], v[46:47] neg_lo:[0,1] neg_hi:[0,1]
    v_lshlrev_b32 v56, 16, v22
    v_and_b32 v57, 0xffff0000, v22
    v_pk_add_f32 v[56:57], v[56:57], v[46:47] neg_lo:[0,1] neg_hi:[0,1]
    v_lshlrev_b32 v58, 16, v23
    v_and_b32 v59, 0xffff0000, v23
    v_pk_add_f32 v[58:59], v[58:59], v[46:47] neg_lo:[0,1] neg_hi:[0,1]
    v_cvt_pk_bf16_f32 v20, v52, v53
    v_cvt_pk_bf16_f32 v21, v54, v55
    v_cvt_pk_bf16_f32 v22, v56, v57
    v_cvt_pk_bf16_f32 v23, v58, v59
    v_lshlrev_b32 v52, 16, v20
    v_and_b32 v53, 0xffff0000, v20
    v_pk_mul_f32 v[52:53], v[52:53], v[48:49]
    v_lshlrev_b32 v54, 16, v21
    v_and_b32 v55, 0xffff0000, v21
    v_pk_mul_f32 v[54:55], v[54:55], v[48:49]
    v_lshlrev_b32 v56, 16, v22
    v_and_b32 v57, 0xffff0000, v22
    v_pk_mul_f32 v[56:57], v[56:57], v[48:49]
    v_lshlrev_b32 v58, 16, v23
    v_and_b32 v59, 0xffff0000, v23
    v_pk_mul_f32 v[58:59], v[58:59], v[48:49]
    v_cvt_pk_bf16_f32 v20, v52, v53
    v_cvt_pk_bf16_f32 v21, v54, v55
    v_cvt_pk_bf16_f32 v22, v56, v57
    v_cvt_pk_bf16_f32 v23, v58, v59
    ds_write_b128 v4, v[20:23] offset:128
    v_lshlrev_b32 v52, 16, v24
    v_and_b32 v53, 0xffff0000, v24
    v_pk_add_f32 v[52:53], v[52:53], v[46:47] neg_lo:[0,1] neg_hi:[0,1]
    v_lshlrev_b32 v54, 16, v25
    v_and_b32 v55, 0xffff0000, v25
    v_pk_add_f32 v[54:55], v[54:55], v[46:47] neg_lo:[0,1] neg_hi:[0,1]
    v_lshlrev_b32 v56, 16, v26
    v_and_b32 v57, 0xffff0000, v26
    v_pk_add_f32 v[56:57], v[56:57], v[46:47] neg_lo:[0,1] neg_hi:[0,1]
    v_lshlrev_b32 v58, 16, v27
    v_and_b32 v59, 0xffff0000, v27
    v_pk_add_f32 v[58:59], v[58:59], v[46:47] neg_lo:[0,1] neg_hi:[0,1]
    v_cvt_pk_bf16_f32 v24, v52, v53
    v_cvt_pk_bf16_f32 v25, v54, v55
    v_cvt_pk_bf16_f32 v26, v56, v57
    v_cvt_pk_bf16_f32 v27, v58, v59
    v_lshlrev_b32 v52, 16, v24
    v_and_b32 v53, 0xffff0000, v24
    v_pk_mul_f32 v[52:53], v[52:53], v[48:49]
    v_lshlrev_b32 v54, 16, v25
    v_and_b32 v55, 0xffff0000, v25
    v_pk_mul_f32 v[54:55], v[54:55], v[48:49]
    v_lshlrev_b32 v56, 16, v26
    v_and_b32 v57, 0xffff0000, v26
    v_pk_mul_f32 v[56:57], v[56:57], v[48:49]
    v_lshlrev_b32 v58, 16, v27
    v_and_b32 v59, 0xffff0000, v27
    v_pk_mul_f32 v[58:59], v[58:59], v[48:49]
    v_cvt_pk_bf16_f32 v24, v52, v53
    v_cvt_pk_bf16_f32 v25, v54, v55
    v_cvt_pk_bf16_f32 v26, v56, v57
    v_cvt_pk_bf16_f32 v27, v58, v59
    ds_write_b128 v4, v[24:27] offset:256
    v_lshlrev_b32 v52, 16, v28
    v_and_b32 v53, 0xffff0000, v28
    v_pk_add_f32 v[52:53], v[52:53], v[46:47] neg_lo:[0,1] neg_hi:[0,1]
    v_lshlrev_b32 v54, 16, v29
    v_and_b32 v55, 0xffff0000, v29
    v_pk_add_f32 v[54:55], v[54:55], v[46:47] neg_lo:[0,1] neg_hi:[0,1]
    v_lshlrev_b32 v56, 16, v30
    v_and_b32 v57, 0xffff0000, v30
    v_pk_add_f32 v[56:57], v[56:57], v[46:47] neg_lo:[0,1] neg_hi:[0,1]
    v_lshlrev_b32 v58, 16, v31
    v_and_b32 v59, 0xffff0000, v31
    v_pk_add_f32 v[58:59], v[58:59], v[46:47] neg_lo:[0,1] neg_hi:[0,1]
    v_cvt_pk_bf16_f32 v28, v52, v53
    v_cvt_pk_bf16_f32 v29, v54, v55
    v_cvt_pk_bf16_f32 v30, v56, v57
    v_cvt_pk_bf16_f32 v31, v58, v59
    v_lshlrev_b32 v52, 16, v28
    v_and_b32 v53, 0xffff0000, v28
    v_pk_mul_f32 v[52:53], v[52:53], v[48:49]
    v_lshlrev_b32 v54, 16, v29
    v_and_b32 v55, 0xffff0000, v29
    v_pk_mul_f32 v[54:55], v[54:55], v[48:49]
    v_lshlrev_b32 v56, 16, v30
    v_and_b32 v57, 0xffff0000, v30
    v_pk_mul_f32 v[56:57], v[56:57], v[48:49]
    v_lshlrev_b32 v58, 16, v31
    v_and_b32 v59, 0xffff0000, v31
    v_pk_mul_f32 v[58:59], v[58:59], v[48:49]
    v_cvt_pk_bf16_f32 v28, v52, v53
    v_cvt_pk_bf16_f32 v29, v54, v55
    v_cvt_pk_bf16_f32 v30, v56, v57
    v_cvt_pk_bf16_f32 v31, v58, v59
    ds_write_b128 v4, v[28:31] offset:384
    v_lshlrev_b32 v52, 16, v32
    v_and_b32 v53, 0xffff0000, v32
    v_pk_add_f32 v[52:53], v[52:53], v[46:47] neg_lo:[0,1] neg_hi:[0,1]
    v_lshlrev_b32 v54, 16, v33
    v_and_b32 v55, 0xffff0000, v33
    v_pk_add_f32 v[54:55], v[54:55], v[46:47] neg_lo:[0,1] neg_hi:[0,1]
    v_lshlrev_b32 v56, 16, v34
    v_and_b32 v57, 0xffff0000, v34
    v_pk_add_f32 v[56:57], v[56:57], v[46:47] neg_lo:[0,1] neg_hi:[0,1]
    v_lshlrev_b32 v58, 16, v35
    v_and_b32 v59, 0xffff0000, v35
    v_pk_add_f32 v[58:59], v[58:59], v[46:47] neg_lo:[0,1] neg_hi:[0,1]
    v_cvt_pk_bf16_f32 v32, v52, v53
    v_cvt_pk_bf16_f32 v33, v54, v55
    v_cvt_pk_bf16_f32 v34, v56, v57
    v_cvt_pk_bf16_f32 v35, v58, v59
    v_lshlrev_b32 v52, 16, v32
    v_and_b32 v53, 0xffff0000, v32
    v_pk_mul_f32 v[52:53], v[52:53], v[48:49]
    v_lshlrev_b32 v54, 16, v33
    v_and_b32 v55, 0xffff0000, v33
    v_pk_mul_f32 v[54:55], v[54:55], v[48:49]
    v_lshlrev_b32 v56, 16, v34
    v_and_b32 v57, 0xffff0000, v34
    v_pk_mul_f32 v[56:57], v[56:57], v[48:49]
    v_lshlrev_b32 v58, 16, v35
    v_and_b32 v59, 0xffff0000, v35
    v_pk_mul_f32 v[58:59], v[58:59], v[48:49]
    v_cvt_pk_bf16_f32 v32, v52, v53
    v_cvt_pk_bf16_f32 v33, v54, v55
    v_cvt_pk_bf16_f32 v34, v56, v57
    v_cvt_pk_bf16_f32 v35, v58, v59
    ds_write_b128 v4, v[32:35] offset:512
    v_lshlrev_b32 v52, 16, v36
    v_and_b32 v53, 0xffff0000, v36
    v_pk_add_f32 v[52:53], v[52:53], v[46:47] neg_lo:[0,1] neg_hi:[0,1]
    v_lshlrev_b32 v54, 16, v37
    v_and_b32 v55, 0xffff0000, v37
    v_pk_add_f32 v[54:55], v[54:55], v[46:47] neg_lo:[0,1] neg_hi:[0,1]
    v_lshlrev_b32 v56, 16, v38
    v_and_b32 v57, 0xffff0000, v38
    v_pk_add_f32 v[56:57], v[56:57], v[46:47] neg_lo:[0,1] neg_hi:[0,1]
    v_lshlrev_b32 v58, 16, v39
    v_and_b32 v59, 0xffff0000, v39
    v_pk_add_f32 v[58:59], v[58:59], v[46:47] neg_lo:[0,1] neg_hi:[0,1]
    v_cvt_pk_bf16_f32 v36, v52, v53
    v_cvt_pk_bf16_f32 v37, v54, v55
    v_cvt_pk_bf16_f32 v38, v56, v57
    v_cvt_pk_bf16_f32 v39, v58, v59
    v_lshlrev_b32 v52, 16, v36
    v_and_b32 v53, 0xffff0000, v36
    v_pk_mul_f32 v[52:53], v[52:53], v[48:49]
    v_lshlrev_b32 v54, 16, v37
    v_and_b32 v55, 0xffff0000, v37
    v_pk_mul_f32 v[54:55], v[54:55], v[48:49]
    v_lshlrev_b32 v56, 16, v38
    v_and_b32 v57, 0xffff0000, v38
    v_pk_mul_f32 v[56:57], v[56:57], v[48:49]
    v_lshlrev_b32 v58, 16, v39
    v_and_b32 v59, 0xffff0000, v39
    v_pk_mul_f32 v[58:59], v[58:59], v[48:49]
    v_cvt_pk_bf16_f32 v36, v52, v53
    v_cvt_pk_bf16_f32 v37, v54, v55
    v_cvt_pk_bf16_f32 v38, v56, v57
    v_cvt_pk_bf16_f32 v39, v58, v59
    ds_write_b128 v4, v[36:39] offset:640
    v_lshlrev_b32 v52, 16, v40
    v_and_b32 v53, 0xffff0000, v40
    v_pk_add_f32 v[52:53], v[52:53], v[46:47] neg_lo:[0,1] neg_hi:[0,1]
    v_lshlrev_b32 v54, 16, v41
    v_and_b32 v55, 0xffff0000, v41
    v_pk_add_f32 v[54:55], v[54:55], v[46:47] neg_lo:[0,1] neg_hi:[0,1]
    v_lshlrev_b32 v56, 16, v42
    v_and_b32 v57, 0xffff0000, v42
    v_pk_add_f32 v[56:57], v[56:57], v[46:47] neg_lo:[0,1] neg_hi:[0,1]
    v_lshlrev_b32 v58, 16, v43
    v_and_b32 v59, 0xffff0000, v43
    v_pk_add_f32 v[58:59], v[58:59], v[46:47] neg_lo:[0,1] neg_hi:[0,1]
    v_cvt_pk_bf16_f32 v40, v52, v53
    v_cvt_pk_bf16_f32 v41, v54, v55
    v_cvt_pk_bf16_f32 v42, v56, v57
    v_cvt_pk_bf16_f32 v43, v58, v59
    v_lshlrev_b32 v52, 16, v40
    v_and_b32 v53, 0xffff0000, v40
    v_pk_mul_f32 v[52:53], v[52:53], v[48:49]
    v_lshlrev_b32 v54, 16, v41
    v_and_b32 v55, 0xffff0000, v41
    v_pk_mul_f32 v[54:55], v[54:55], v[48:49]
    v_lshlrev_b32 v56, 16, v42
    v_and_b32 v57, 0xffff0000, v42
    v_pk_mul_f32 v[56:57], v[56:57], v[48:49]
    v_lshlrev_b32 v58, 16, v43
    v_and_b32 v59, 0xffff0000, v43
    v_pk_mul_f32 v[58:59], v[58:59], v[48:49]
    v_cvt_pk_bf16_f32 v40, v52, v53
    v_cvt_pk_bf16_f32 v41, v54, v55
    v_cvt_pk_bf16_f32 v42, v56, v57
    v_cvt_pk_bf16_f32 v43, v58, v59
    ds_write_b128 v4, v[40:43] offset:768
    v_and_b32 v5, 15, v0
    v_bfe_u32 v6, v0, 4, 2
    v_lshrrev_b32 v7, 6, v0
    v_lshrrev_b32 v8, 2, v5
    v_lshl_add_u32 v8, v6, 3, v8
    v_mul_u32_u24 v8, 928, v8
    v_lshl_add_u32 v8, v6, 7, v8
    v_lshl_add_u32 v8, v7, 5, v8
    v_and_b32 v9, 3, v5
    v_lshl_add_u32 v8, v9, 3, v8
    v_mul_u32_u24 v12, 7168, v7
    v_add_u32 v12, 36864, v12
    v_lshl_add_u32 v13, v5, 6, v12
    v_lshl_add_u32 v13, v6, 4, v13
    v_and_b32 v14, 63, v0
    v_lshl_add_u32 v12, v14, 4, v12
    v_lshlrev_b32 v9, 4, v14
    v_lshl_add_u32 v9, v7, 10, v9
    v_add_u32 v9, s6, v9
    s_add_u32 s10, s8, 1048576
    s_addc_u32 s11, s9, 0
    v_lshlrev_b32 v10, 2, v1
    s_waitcnt lgkmcnt(0)
    s_barrier
    ds_read_b64_tr_b16 v[16:17], v8 offset:0
    ds_read_b64_tr_b16 v[18:19], v8 offset:3712
    ds_read_b64_tr_b16 v[20:21], v8 offset:128
    ds_read_b64_tr_b16 v[22:23], v8 offset:3840
    ds_read_b64_tr_b16 v[24:25], v8 offset:256
    ds_read_b64_tr_b16 v[26:27], v8 offset:3968
    ds_read_b64_tr_b16 v[28:29], v8 offset:384
    ds_read_b64_tr_b16 v[30:31], v8 offset:4096
    ds_read_b64_tr_b16 v[32:33], v8 offset:512
    ds_read_b64_tr_b16 v[34:35], v8 offset:4224
    ds_read_b64_tr_b16 v[36:37], v8 offset:640
    ds_read_b64_tr_b16 v[38:39], v8 offset:4352
    ds_read_b64_tr_b16 v[40:41], v8 offset:768
    ds_read_b64_tr_b16 v[42:43], v8 offset:4480
    s_waitcnt lgkmcnt(12)
    ds_write_b128 v13, v[16:19] offset:0
    s_waitcnt lgkmcnt(11)
    ds_write_b128 v13, v[20:23] offset:1024
    s_waitcnt lgkmcnt(10)
    ds_write_b128 v13, v[24:27] offset:2048
    s_waitcnt lgkmcnt(9)
    ds_write_b128 v13, v[28:31] offset:3072
    s_waitcnt lgkmcnt(8)
    ds_write_b128 v13, v[32:35] offset:4096
    s_waitcnt lgkmcnt(7)
    ds_write_b128 v13, v[36:39] offset:5120
    s_waitcnt lgkmcnt(6)
    ds_write_b128 v13, v[40:43] offset:6144
    s_waitcnt lgkmcnt(0)
    ds_read_b128 v[16:19], v12 offset:0
    ds_read_b128 v[20:23], v12 offset:1024
    ds_read_b128 v[24:27], v12 offset:2048
    ds_read_b128 v[28:31], v12 offset:3072
    ds_read_b128 v[32:35], v12 offset:4096
    ds_read_b128 v[36:39], v12 offset:5120
    ds_read_b128 v[40:43], v12 offset:6144
    s_waitcnt lgkmcnt(6)
    global_store_dwordx4 v9, v[16:19], s[10:11]
    s_waitcnt lgkmcnt(5)
    v_add_u32 v9, 4096, v9
    global_store_dwordx4 v9, v[20:23], s[10:11]
    s_waitcnt lgkmcnt(4)
    v_add_u32 v9, 4096, v9
    global_store_dwordx4 v9, v[24:27], s[10:11]
    s_waitcnt lgkmcnt(3)
    v_add_u32 v9, 4096, v9
    global_store_dwordx4 v9, v[28:31], s[10:11]
    s_waitcnt lgkmcnt(2)
    v_add_u32 v9, 4096, v9
    global_store_dwordx4 v9, v[32:35], s[10:11]
    s_waitcnt lgkmcnt(1)
    v_add_u32 v9, 4096, v9
    global_store_dwordx4 v9, v[36:39], s[10:11]
    s_waitcnt lgkmcnt(0)
    v_add_u32 v9, 4096, v9
    global_store_dwordx4 v9, v[40:43], s[10:11]
    s_cmp_ge_u32 s2, 42
    s_cbranch_scc1 K1_LNEND
    ds_read_b32 v44, v10 offset:30208
    ds_read_b32 v45, v10 offset:30336
    ds_read_b32 v46, v10 offset:30464
    ds_read_b32 v47, v10 offset:30592
    ds_read_b32 v48, v10 offset:30720
    ds_read_b32 v49, v10 offset:30848
    ds_read_b32 v50, v10 offset:30976
    ds_read_b32 v51, v10 offset:31104
    ds_read_b32 v52, v10 offset:31232
    ds_read_b32 v53, v10 offset:31360
    ds_read_b32 v54, v10 offset:31488
    ds_read_b32 v55, v10 offset:31616
    ds_read_b32 v56, v10 offset:31744
    ds_read_b32 v57, v10 offset:31872
    v_mov_b32 v120, 0
    v_mov_b32 v121, 0
    v_mov_b32 v122, 0
    v_mov_b32 v123, 0
    v_mov_b32 v124, 0
    v_mov_b32 v125, 0
    v_mov_b32 v126, 0
    v_mov_b32 v127, 0
    s_waitcnt vmcnt(7) lgkmcnt(0)
    v_lshlrev_b32 v58, 16, v64
    v_and_b32 v59, 0xffff0000, v64
    v_fmac_f32 v120, v44, v58
    v_fmac_f32 v121, v44, v59
    v_lshlrev_b32 v58, 16, v65
    v_and_b32 v59, 0xffff0000, v65
    v_fmac_f32 v122, v44, v58
    v_fmac_f32 v123, v44, v59
    v_lshlrev_b32 v58, 16, v66
    v_and_b32 v59, 0xffff0000, v66
    v_fmac_f32 v124, v44, v58
    v_fmac_f32 v125, v44, v59
    v_lshlrev_b32 v58, 16, v67
    v_and_b32 v59, 0xffff0000, v67
    v_fmac_f32 v126, v44, v58
    v_fmac_f32 v127, v44, v59
    v_lshlrev_b32 v58, 16, v68
    v_and_b32 v59, 0xffff0000, v68
    v_fmac_f32 v120, v45, v58
    v_fmac_f32 v121, v45, v59
    v_lshlrev_b32 v58, 16, v69
    v_and_b32 v59, 0xffff0000, v69
    v_fmac_f32 v122, v45, v58
    v_fmac_f32 v123, v45, v59
    v_lshlrev_b32 v58, 16, v70
    v_and_b32 v59, 0xffff0000, v70
    v_fmac_f32 v124, v45, v58
    v_fmac_f32 v125, v45, v59
    v_lshlrev_b32 v58, 16, v71
    v_and_b32 v59, 0xffff0000, v71
    v_fmac_f32 v126, v45, v58
    v_fmac_f32 v127, v45, v59
    v_lshlrev_b32 v58, 16, v72
    v_and_b32 v59, 0xffff0000, v72
    v_fmac_f32 v120, v46, v58
    v_fmac_f32 v121, v46, v59
    v_lshlrev_b32 v58, 16, v73
    v_and_b32 v59, 0xffff0000, v73
    v_fmac_f32 v122, v46, v58
    v_fmac_f32 v123, v46, v59
    v_lshlrev_b32 v58, 16, v74
    v_and_b32 v59, 0xffff0000, v74
    v_fmac_f32 v124, v46, v58
    v_fmac_f32 v125, v46, v59
    v_lshlrev_b32 v58, 16, v75
    v_and_b32 v59, 0xffff0000, v75
    v_fmac_f32 v126, v46, v58
    v_fmac_f32 v127, v46, v59
    v_lshlrev_b32 v58, 16, v76
    v_and_b32 v59, 0xffff0000, v76
    v_fmac_f32 v120, v47, v58
    v_fmac_f32 v121, v47, v59
    v_lshlrev_b32 v58, 16, v77
    v_and_b32 v59, 0xffff0000, v77
    v_fmac_f32 v122, v47, v58
    v_fmac_f32 v123, v47, v59
    v_lshlrev_b32 v58, 16, v78
    v_and_b32 v59, 0xffff0000, v78
    v_fmac_f32 v124, v47, v58
    v_fmac_f32 v125, v47, v59
    v_lshlrev_b32 v58, 16, v79
    v_and_b32 v59, 0xffff0000, v79
    v_fmac_f32 v126, v47, v58
    v_fmac_f32 v127, v47, v59
    v_lshlrev_b32 v58, 16, v80
    v_and_b32 v59, 0xffff0000, v80
    v_fmac_f32 v120, v48, v58
    v_fmac_f32 v121, v48, v59
    v_lshlrev_b32 v58, 16, v81
    v_and_b32 v59, 0xffff0000, v81
    v_fmac_f32 v122, v48, v58
    v_fmac_f32 v123, v48, v59
    v_lshlrev_b32 v58, 16, v82
    v_and_b32 v59, 0xffff0000, v82
    v_fmac_f32 v124, v48, v58
    v_fmac_f32 v125, v48, v59
    v_lshlrev_b32 v58, 16, v83
    v_and_b32 v59, 0xffff0000, v83
    v_fmac_f32 v126, v48, v58
    v_fmac_f32 v127, v48, v59
    v_lshlrev_b32 v58, 16, v84
    v_and_b32 v59, 0xffff0000, v84
    v_fmac_f32 v120, v49, v58
    v_fmac_f32 v121, v49, v59
    v_lshlrev_b32 v58, 16, v85
    v_and_b32 v59, 0xffff0000, v85
    v_fmac_f32 v122, v49, v58
    v_fmac_f32 v123, v49, v59
    v_lshlrev_b32 v58, 16, v86
    v_and_b32 v59, 0xffff0000, v86
    v_fmac_f32 v124, v49, v58
    v_fmac_f32 v125, v49, v59
    v_lshlrev_b32 v58, 16, v87
    v_and_b32 v59, 0xffff0000, v87
    v_fmac_f32 v126, v49, v58
    v_fmac_f32 v127, v49, v59
    v_lshlrev_b32 v58, 16, v88
    v_and_b32 v59, 0xffff0000, v88
    v_fmac_f32 v120, v50, v58
    v_fmac_f32 v121, v50, v59
    v_lshlrev_b32 v58, 16, v89
    v_and_b32 v59, 0xffff0000, v89
    v_fmac_f32 v122, v50, v58
    v_fmac_f32 v123, v50, v59
    v_lshlrev_b32 v58, 16, v90
    v_and_b32 v59, 0xffff0000, v90
    v_fmac_f32 v124, v50, v58
    v_fmac_f32 v125, v50, v59
    v_lshlrev_b32 v58, 16, v91
    v_and_b32 v59, 0xffff0000, v91
    v_fmac_f32 v126, v50, v58
    v_fmac_f32 v127, v50, v59
    v_lshlrev_b32 v58, 16, v92
    v_and_b32 v59, 0xffff0000, v92
    v_fmac_f32 v120, v51, v58
    v_fmac_f32 v121, v51, v59
    v_lshlrev_b32 v58, 16, v93
    v_and_b32 v59, 0xffff0000, v93
    v_fmac_f32 v122, v51, v58
    v_fmac_f32 v123, v51, v59
    v_lshlrev_b32 v58, 16, v94
    v_and_b32 v59, 0xffff0000, v94
    v_fmac_f32 v124, v51, v58
    v_fmac_f32 v125, v51, v59
    v_lshlrev_b32 v58, 16, v95
    v_and_b32 v59, 0xffff0000, v95
    v_fmac_f32 v126, v51, v58
    v_fmac_f32 v127, v51, v59
    v_lshlrev_b32 v58, 16, v96
    v_and_b32 v59, 0xffff0000, v96
    v_fmac_f32 v120, v52, v58
    v_fmac_f32 v121, v52, v59
    v_lshlrev_b32 v58, 16, v97
    v_and_b32 v59, 0xffff0000, v97
    v_fmac_f32 v122, v52, v58
    v_fmac_f32 v123, v52, v59
    v_lshlrev_b32 v58, 16, v98
    v_and_b32 v59, 0xffff0000, v98
    v_fmac_f32 v124, v52, v58
    v_fmac_f32 v125, v52, v59
    v_lshlrev_b32 v58, 16, v99
    v_and_b32 v59, 0xffff0000, v99
    v_fmac_f32 v126, v52, v58
    v_fmac_f32 v127, v52, v59
    v_lshlrev_b32 v58, 16, v100
    v_and_b32 v59, 0xffff0000, v100
    v_fmac_f32 v120, v53, v58
    v_fmac_f32 v121, v53, v59
    v_lshlrev_b32 v58, 16, v101
    v_and_b32 v59, 0xffff0000, v101
    v_fmac_f32 v122, v53, v58
    v_fmac_f32 v123, v53, v59
    v_lshlrev_b32 v58, 16, v102
    v_and_b32 v59, 0xffff0000, v102
    v_fmac_f32 v124, v53, v58
    v_fmac_f32 v125, v53, v59
    v_lshlrev_b32 v58, 16, v103
    v_and_b32 v59, 0xffff0000, v103
    v_fmac_f32 v126, v53, v58
    v_fmac_f32 v127, v53, v59
    v_lshlrev_b32 v58, 16, v104
    v_and_b32 v59, 0xffff0000, v104
    v_fmac_f32 v120, v54, v58
    v_fmac_f32 v121, v54, v59
    v_lshlrev_b32 v58, 16, v105
    v_and_b32 v59, 0xffff0000, v105
    v_fmac_f32 v122, v54, v58
    v_fmac_f32 v123, v54, v59
    v_lshlrev_b32 v58, 16, v106
    v_and_b32 v59, 0xffff0000, v106
    v_fmac_f32 v124, v54, v58
    v_fmac_f32 v125, v54, v59
    v_lshlrev_b32 v58, 16, v107
    v_and_b32 v59, 0xffff0000, v107
    v_fmac_f32 v126, v54, v58
    v_fmac_f32 v127, v54, v59
    v_lshlrev_b32 v58, 16, v108
    v_and_b32 v59, 0xffff0000, v108
    v_fmac_f32 v120, v55, v58
    v_fmac_f32 v121, v55, v59
    v_lshlrev_b32 v58, 16, v109
    v_and_b32 v59, 0xffff0000, v109
    v_fmac_f32 v122, v55, v58
    v_fmac_f32 v123, v55, v59
    v_lshlrev_b32 v58, 16, v110
    v_and_b32 v59, 0xffff0000, v110
    v_fmac_f32 v124, v55, v58
    v_fmac_f32 v125, v55, v59
    v_lshlrev_b32 v58, 16, v111
    v_and_b32 v59, 0xffff0000, v111
    v_fmac_f32 v126, v55, v58
    v_fmac_f32 v127, v55, v59
    v_lshlrev_b32 v58, 16, v112
    v_and_b32 v59, 0xffff0000, v112
    v_fmac_f32 v120, v56, v58
    v_fmac_f32 v121, v56, v59
    v_lshlrev_b32 v58, 16, v113
    v_and_b32 v59, 0xffff0000, v113
    v_fmac_f32 v122, v56, v58
    v_fmac_f32 v123, v56, v59
    v_lshlrev_b32 v58, 16, v114
    v_and_b32 v59, 0xffff0000, v114
    v_fmac_f32 v124, v56, v58
    v_fmac_f32 v125, v56, v59
    v_lshlrev_b32 v58, 16, v115
    v_and_b32 v59, 0xffff0000, v115
    v_fmac_f32 v126, v56, v58
    v_fmac_f32 v127, v56, v59
    v_lshlrev_b32 v58, 16, v116
    v_and_b32 v59, 0xffff0000, v116
    v_fmac_f32 v120, v57, v58
    v_fmac_f32 v121, v57, v59
    v_lshlrev_b32 v58, 16, v117
    v_and_b32 v59, 0xffff0000, v117
    v_fmac_f32 v122, v57, v58
    v_fmac_f32 v123, v57, v59
    v_lshlrev_b32 v58, 16, v118
    v_and_b32 v59, 0xffff0000, v118
    v_fmac_f32 v124, v57, v58
    v_fmac_f32 v125, v57, v59
    v_lshlrev_b32 v58, 16, v119
    v_and_b32 v59, 0xffff0000, v119
    v_fmac_f32 v126, v57, v58
    v_fmac_f32 v127, v57, v59
    v_add_f32_dpp v120, v120, v120 row_ror:8 row_mask:0xf bank_mask:0xf
    v_add_f32_dpp v121, v121, v121 row_ror:8 row_mask:0xf bank_mask:0xf
    v_add_f32_dpp v122, v122, v122 row_ror:8 row_mask:0xf bank_mask:0xf
    v_add_f32_dpp v123, v123, v123 row_ror:8 row_mask:0xf bank_mask:0xf
    v_add_f32_dpp v124, v124, v124 row_ror:8 row_mask:0xf bank_mask:0xf
    v_add_f32_dpp v125, v125, v125 row_ror:8 row_mask:0xf bank_mask:0xf
    v_add_f32_dpp v126, v126, v126 row_ror:8 row_mask:0xf bank_mask:0xf
    v_add_f32_dpp v127, v127, v127 row_ror:8 row_mask:0xf bank_mask:0xf
    v_mov_b32 v44, v120
    v_mov_b32 v45, v121
    v_mov_b32 v46, v122
    v_mov_b32 v47, v123
    v_mov_b32 v48, v124
    v_mov_b32 v49, v125
    v_mov_b32 v50, v126
    v_mov_b32 v51, v127
    v_permlane32_swap_b32 v120, v44
    v_permlane32_swap_b32 v121, v45
    v_permlane32_swap_b32 v122, v46
    v_permlane32_swap_b32 v123, v47
    v_permlane32_swap_b32 v124, v48
    v_permlane32_swap_b32 v125, v49
    v_permlane32_swap_b32 v126, v50
    v_permlane32_swap_b32 v127, v51
    v_add_f32 v120, v120, v44
    v_add_f32 v121, v121, v45
    v_add_f32 v122, v122, v46
    v_add_f32 v123, v123, v47
    v_add_f32 v124, v124, v48
    v_add_f32 v125, v125, v49
    v_add_f32 v126, v126, v50
    v_add_f32 v127, v127, v51
    v_mov_b32 v44, v120
    v_mov_b32 v45, v121
    v_mov_b32 v46, v122
    v_mov_b32 v47, v123
    v_mov_b32 v48, v124
    v_mov_b32 v49, v125
    v_mov_b32 v50, v126
    v_mov_b32 v51, v127
    v_permlane16_swap_b32 v120, v44
    v_permlane16_swap_b32 v121, v45
    v_permlane16_swap_b32 v122, v46
    v_permlane16_swap_b32 v123, v47
    v_permlane16_swap_b32 v124, v48
    v_permlane16_swap_b32 v125, v49
    v_permlane16_swap_b32 v126, v50
    v_permlane16_swap_b32 v127, v51
    v_add_f32 v120, v120, v44
    v_add_f32 v121, v121, v45
    v_add_f32 v122, v122, v46
    v_add_f32 v123, v123, v47
    v_add_f32 v124, v124, v48
    v_add_f32 v125, v125, v49
    v_add_f32 v126, v126, v50
    v_add_f32 v127, v127, v51
    v_lshlrev_b32 v4, 5, v2
    v_lshl_add_u32 v4, v7, 8, v4
    v_cmp_gt_u32 vcc, 8, v14
    s_and_saveexec_b64 s[20:21], vcc
    ds_write_b128 v4, v[120:123] offset:32256
    ds_write_b128 v4, v[124:127] offset:32272
    s_mov_b64 exec, s[20:21]
    s_waitcnt lgkmcnt(0)
    s_barrier
    v_cmp_gt_u32 vcc, 64, v0
    s_and_saveexec_b64 s[20:21], vcc
    s_cbranch_execz K1_LNEND
    v_lshlrev_b32 v4, 2, v0
    ds_read_b32 v16, v4 offset:32256
    ds_read_b32 v17, v4 offset:32512
    ds_read_b32 v18, v4 offset:32768
    ds_read_b32 v19, v4 offset:33024
    s_lshl_b32 s7, s2, 8
    v_add_u32 v4, s7, v4
    s_waitcnt lgkmcnt(0)
    v_add_f32 v16, v16, v17
    v_add_f32 v18, v18, v19
    v_add_f32 v16, v16, v18
    v_cvt_pk_bf16_f32 v16, v16, v16
    v_lshlrev_b32 v16, 16, v16
    global_store_dword v4, v16, s[8:9] offset:0
    v_add_f32 v17, 1.0, v16
    v_cvt_pk_bf16_f32 v17, v17, v17
    v_lshlrev_b32 v17, 16, v17
    s_cmp_lt_u32 s2, 7
    s_cbranch_scc1 K1_LNEND
    s_cmp_lt_u32 s2, 14
    s_cbranch_scc1 K1_MOD_A
    s_cmp_lt_u32 s2, 28
    s_cbranch_scc1 K1_LNEND
    s_cmp_ge_u32 s2, 35
    s_cbranch_scc1 K1_LNEND
    global_store_dword v4, v17, s[8:9] offset:3584
    s_branch K1_LNEND
K1_MOD_A:
    v_add_u32 v4, 6*1792, v4
    global_store_dword v4, v17, s[8:9] offset:0
K1_LNEND:
    s_endpgm
K1_KGEN:
    s_load_dwordx8 s[4:11], s[0:1], 8
    s_load_dwordx4 s[12:15], s[0:1], 40
    s_load_dwordx2 s[16:17], s[0:1], 56
    s_load_dwordx2 s[18:19], s[0:1], 144
    s_sub_u32 s3, s2, 64
    s_lshl_b32 s20, s3, 9
    v_lshl_add_u32 v1, v0, 1, s20
    s_lshl_b32 s21, s3, 1
    v_mov_b32 v2, s21
    s_waitcnt lgkmcnt(0)
    global_load_ushort v4, v1, s[4:5]
    global_load_ushort v5, v1, s[6:7]
    global_load_ushort v6, v1, s[8:9]
    global_load_ushort v7, v1, s[10:11]
    global_load_ushort v8, v1, s[12:13]
    global_load_ushort v9, v1, s[14:15]
    global_load_ushort v10, v2, s[16:17]
    v_lshlrev_b32 v112, 2, v0
    v_xor_b32 v113, 16, v112
    v_xor_b32 v114, 32, v112
    v_xor_b32 v115, 48, v112
    v_xor_b32 v116, 64, v112
    v_xor_b32 v117, 80, v112
    v_xor_b32 v118, 96, v112
    v_xor_b32 v119, 112, v112
    v_xor_b32 v120, 128, v112
    v_xor_b32 v121, 144, v112
    v_xor_b32 v122, 160, v112
    v_xor_b32 v123, 176, v112
    v_xor_b32 v124, 192, v112
    v_xor_b32 v125, 208, v112
    v_xor_b32 v126, 224, v112
    v_xor_b32 v127, 240, v112
    s_waitcnt vmcnt(0)
    v_lshlrev_b32 v4, 16, v4
    v_lshlrev_b32 v5, 16, v5
    v_lshlrev_b32 v6, 16, v6
    v_lshlrev_b32 v7, 16, v7
    v_lshlrev_b32 v8, 16, v8
    v_lshlrev_b32 v9, 16, v9
    v_lshlrev_b32 v10, 16, v10
    v_mul_f32 v10, 0x3fb8aa3b, v10
    v_exp_f32 v10, v10
    s_nop 0
    v_cvt_pk_bf16_f32 v10, v10, v10
    v_lshlrev_b32 v10, 16, v10
    v_mul_f32 v4, v10, v4
    v_mul_f32 v5, v10, v5
    v_mul_f32 v6, v10, v6
    v_mul_f32 v7, v10, v7
    v_mul_f32 v11, v9, v7
    v_fma_f32 v12, v8, v6, -v11
    v_mul_f32 v11, v9, v6
    v_fma_f32 v13, v8, v7, v11
    v_max_f32 v11, |v12|, |v13|
    s_nop 1
    v_max_f32_dpp v11, v11, v11 row_shr:1 row_mask:0xf bank_mask:0xf
    s_nop 1
    v_max_f32_dpp v11, v11, v11 row_shr:2 row_mask:0xf bank_mask:0xf
    s_nop 1
    v_max_f32_dpp v11, v11, v11 row_shr:4 row_mask:0xf bank_mask:0xf
    s_nop 1
    v_max_f32_dpp v11, v11, v11 row_shr:8 row_mask:0xf bank_mask:0xf
    s_nop 1
    v_max_f32_dpp v11, v11, v11 row_bcast:15 row_mask:0xa bank_mask:0xf
    s_nop 1
    v_max_f32_dpp v11, v11, v11 row_bcast:31 row_mask:0xc bank_mask:0xf
    s_nop 0
    v_readlane_b32 s22, v11, 63
    v_lshrrev_b32 v14, 6, v0
    v_lshlrev_b32 v14, 2, v14
    v_mov_b32 v15, s22
    ds_write_b32 v14, v15 offset:4352
    v_mul_f32 v4, 0x3fb8aa3b, v4
    v_mul_f32 v5, 0x3e22f983, v5
    v_mul_f32 v16, 0x3f800000, v4
    v_mul_f32 v17, 0x3f800000, v5
    v_exp_f32 v16, v16
    v_fract_f32 v17, v17
    v_cos_f32 v20, v17
    v_sin_f32 v21, v17
    v_mul_f32 v20, v20, v16
    v_mul_f32 v21, v21, v16
    v_mul_f32 v16, 0x41000000, v4
    v_mul_f32 v17, 0x41000000, v5
    v_exp_f32 v16, v16
    v_fract_f32 v17, v17
    v_cos_f32 v34, v17
    v_sin_f32 v35, v17
    v_mul_f32 v34, v34, v16
    v_mul_f32 v35, v35, v16
    v_mul_f32 v16, 0x43000000, v4
    v_mul_f32 v17, 0x43000000, v5
    v_exp_f32 v16, v16
    v_fract_f32 v17, v17
    v_cos_f32 v64, v17
    v_sin_f32 v65, v17
    v_mul_f32 v64, v64, v16
    v_mul_f32 v65, v65, v16
    s_waitcnt lgkmcnt(0)
    s_barrier
    v_mov_b32 v14, 0
    ds_read_b128 v[16:19], v14 offset:4352
    s_waitcnt lgkmcnt(0)
    v_max3_f32 v16, v16, v17, v18
    v_max_f32 v16, v16, v19
    v_frexp_exp_i32_f32 v16, v16
    v_mov_b32 v17, 100
    v_min_i32 v16, v16, v17
    v_sub_u32 v17, 0, v17
    v_max_i32 v16, v16, v17
    v_sub_u32 v17, 15, v16
    v_ldexp_f32 v96, v12, v17
    v_ldexp_f32 v97, v13, v17
    v_add_u32 v17, -7, v16
    v_ldexp_f32 v15, 1.0, v17
    v_mul_f32 v16, v35, v35
    v_mul_f32 v17, v35, v34
    v_fma_f32 v36, v34, v34, -v16
    v_fma_f32 v37, v34, v35, v17
    v_mul_f32 v16, v37, v35
    v_mul_f32 v17, v37, v34
    v_fma_f32 v38, v36, v34, -v16
    v_fma_f32 v39, v36, v35, v17
    v_mul_f32 v16, v37, v37
    v_mul_f32 v17, v37, v36
    v_fma_f32 v40, v36, v36, -v16
    v_fma_f32 v41, v36, v37, v17
    v_mul_f32 v16, v41, v35
    v_mul_f32 v17, v41, v34
    v_fma_f32 v42, v40, v34, -v16
    v_fma_f32 v43, v40, v35, v17
    v_mul_f32 v16, v41, v37
    v_mul_f32 v17, v41, v36
    v_fma_f32 v44, v40, v36, -v16
    v_fma_f32 v45, v40, v37, v17
    v_mul_f32 v16, v41, v39
    v_mul_f32 v17, v41, v38
    v_fma_f32 v46, v40, v38, -v16
    v_fma_f32 v47, v40, v39, v17
    v_mul_f32 v16, v41, v41
    v_mul_f32 v17, v41, v40
    v_fma_f32 v48, v40, v40, -v16
    v_fma_f32 v49, v40, v41, v17
    v_mul_f32 v16, v49, v35
    v_mul_f32 v17, v49, v34
    v_fma_f32 v50, v48, v34, -v16
    v_fma_f32 v51, v48, v35, v17
    v_mul_f32 v16, v49, v37
    v_mul_f32 v17, v49, v36
    v_fma_f32 v52, v48, v36, -v16
    v_fma_f32 v53, v48, v37, v17
    v_mul_f32 v16, v49, v39
    v_mul_f32 v17, v49, v38
    v_fma_f32 v54, v48, v38, -v16
    v_fma_f32 v55, v48, v39, v17
    v_mul_f32 v16, v49, v41
    v_mul_f32 v17, v49, v40
    v_fma_f32 v56, v48, v40, -v16
    v_fma_f32 v57, v48, v41, v17
    v_mul_f32 v16, v49, v43
    v_mul_f32 v17, v49, v42
    v_fma_f32 v58, v48, v42, -v16
    v_fma_f32 v59, v48, v43, v17
    v_mul_f32 v16, v49, v45
    v_mul_f32 v17, v49, v44
    v_fma_f32 v60, v48, v44, -v16
    v_fma_f32 v61, v48, v45, v17
    v_mul_f32 v16, v49, v47
    v_mul_f32 v17, v49, v46
    v_fma_f32 v62, v48, v46, -v16
    v_fma_f32 v63, v48, v47, v17
    v_mov_b32 v18, 0x3c00
    ds_write_b32 v112, v18 offset:4608
    v_cvt_pk_f16_f32 v18, v34, -v35
    ds_write_b32 v113, v18 offset:5632
    v_cvt_pk_f16_f32 v18, v36, -v37
    ds_write_b32 v114, v18 offset:6656
    v_cvt_pk_f16_f32 v18, v38, -v39
    ds_write_b32 v115, v18 offset:7680
    v_cvt_pk_f16_f32 v18, v40, -v41
    ds_write_b32 v116, v18 offset:8704
    v_cvt_pk_f16_f32 v18, v42, -v43
    ds_write_b32 v117, v18 offset:9728
    v_cvt_pk_f16_f32 v18, v44, -v45
    ds_write_b32 v118, v18 offset:10752
    v_cvt_pk_f16_f32 v18, v46, -v47
    ds_write_b32 v119, v18 offset:11776
    v_cvt_pk_f16_f32 v18, v48, -v49
    ds_write_b32 v120, v18 offset:12800
    v_cvt_pk_f16_f32 v18, v50, -v51
    ds_write_b32 v121, v18 offset:13824
    v_cvt_pk_f16_f32 v18, v52, -v53
    ds_write_b32 v122, v18 offset:14848
    v_cvt_pk_f16_f32 v18, v54, -v55
    ds_write_b32 v123, v18 offset:15872
    v_cvt_pk_f16_f32 v18, v56, -v57
    ds_write_b32 v124, v18 offset:16896
    v_cvt_pk_f16_f32 v18, v58, -v59
    ds_write_b32 v125, v18 offset:17920
    v_cvt_pk_f16_f32 v18, v60, -v61
    ds_write_b32 v126, v18 offset:18944
    v_cvt_pk_f16_f32 v18, v62, -v63
    ds_write_b32 v127, v18 offset:19968
    v_mul_f32 v16, v21, v21
    v_mul_f32 v17, v21, v20
    v_fma_f32 v22, v20, v20, -v16
    v_fma_f32 v23, v20, v21, v17
    v_mul_f32 v16, v23, v21
    v_mul_f32 v17, v23, v20
    v_fma_f32 v24, v22, v20, -v16
    v_fma_f32 v25, v22, v21, v17
    v_mul_f32 v16, v23, v23
    v_mul_f32 v17, v23, v22
    v_fma_f32 v26, v22, v22, -v16
    v_fma_f32 v27, v22, v23, v17
    v_mul_f32 v16, v27, v21
    v_mul_f32 v17, v27, v20
    v_fma_f32 v28, v26, v20, -v16
    v_fma_f32 v29, v26, v21, v17
    v_mul_f32 v16, v27, v23
    v_mul_f32 v17, v27, v22
    v_fma_f32 v30, v26, v22, -v16
    v_fma_f32 v31, v26, v23, v17
    v_mul_f32 v16, v27, v25
    v_mul_f32 v17, v27, v24
    v_fma_f32 v32, v26, v24, -v16
    v_fma_f32 v33, v26, v25, v17
    v_mul_f32 v16, v65, v65
    v_mul_f32 v17, v65, v64
    v_fma_f32 v66, v64, v64, -v16
    v_fma_f32 v67, v64, v65, v17
    v_mul_f32 v16, v67, v65
    v_mul_f32 v17, v67, v64
    v_fma_f32 v68, v66, v64, -v16
    v_fma_f32 v69, v66, v65, v17
    v_mul_f32 v16, v67, v67
    v_mul_f32 v17, v67, v66
    v_fma_f32 v70, v66, v66, -v16
    v_fma_f32 v71, v66, v67, v17
    v_mul_f32 v16, v71, v65
    v_mul_f32 v17, v71, v64
    v_fma_f32 v72, v70, v64, -v16
    v_fma_f32 v73, v70, v65, v17
    v_mul_f32 v16, v71, v67
    v_mul_f32 v17, v71, v66
    v_fma_f32 v74, v70, v66, -v16
    v_fma_f32 v75, v70, v67, v17
    v_mul_f32 v16, v71, v69
    v_mul_f32 v17, v71, v68
    v_fma_f32 v76, v70, v68, -v16
    v_fma_f32 v77, v70, v69, v17
    v_mul_f32 v16, v71, v71
    v_mul_f32 v17, v71, v70
    v_fma_f32 v78, v70, v70, -v16
    v_fma_f32 v79, v70, v71, v17
    v_mul_f32 v16, v79, v65
    v_mul_f32 v17, v79, v64
    v_fma_f32 v80, v78, v64, -v16
    v_fma_f32 v81, v78, v65, v17
    v_mul_f32 v16, v79, v67
    v_mul_f32 v17, v79, v66
    v_fma_f32 v82, v78, v66, -v16
    v_fma_f32 v83, v78, v67, v17
    v_mul_f32 v16, v79, v69
    v_mul_f32 v17, v79, v68
    v_fma_f32 v84, v78, v68, -v16
    v_fma_f32 v85, v78, v69, v17
    v_mul_f32 v16, v79, v71
    v_mul_f32 v17, v79, v70
    v_fma_f32 v86, v78, v70, -v16
    v_fma_f32 v87, v78, v71, v17
    v_mul_f32 v16, v79, v73
    v_mul_f32 v17, v79, v72
    v_fma_f32 v88, v78, v72, -v16
    v_fma_f32 v89, v78, v73, v17
    v_mul_f32 v16, v79, v75
    v_mul_f32 v17, v79, v74
    v_fma_f32 v90, v78, v74, -v16
    v_fma_f32 v91, v78, v75, v17
    v_mul_f32 v16, v79, v77
    v_mul_f32 v17, v79, v76
    v_fma_f32 v92, v78, v76, -v16
    v_fma_f32 v93, v78, v77, v17
    v_mul_f32 v16, v79, v79
    v_mul_f32 v17, v79, v78
    v_fma_f32 v94, v78, v78, -v16
    v_fma_f32 v95, v78, v79, v17
    v_mul_f32 v16, v97, v21
    v_mul_f32 v17, v97, v20
    v_fma_f32 v98, v96, v20, -v16
    v_fma_f32 v99, v96, v21, v17
    v_mul_f32 v16, v97, v23
    v_mul_f32 v17, v97, v22
    v_fma_f32 v100, v96, v22, -v16
    v_fma_f32 v101, v96, v23, v17
    v_mul_f32 v16, v97, v25
    v_mul_f32 v17, v97, v24
    v_fma_f32 v102, v96, v24, -v16
    v_fma_f32 v103, v96, v25, v17
    v_mul_f32 v16, v97, v27
    v_mul_f32 v17, v97, v26
    v_fma_f32 v104, v96, v26, -v16
    v_fma_f32 v105, v96, v27, v17
    v_mul_f32 v16, v97, v29
    v_mul_f32 v17, v97, v28
    v_fma_f32 v106, v96, v28, -v16
    v_fma_f32 v107, v96, v29, v17
    v_mul_f32 v16, v97, v31
    v_mul_f32 v17, v97, v30
    v_fma_f32 v108, v96, v30, -v16
    v_fma_f32 v109, v96, v31, v17
    v_mul_f32 v16, v97, v33
    v_mul_f32 v17, v97, v32
    v_fma_f32 v110, v96, v32, -v16
    v_fma_f32 v111, v96, v33, v17
    v_cvt_pk_f16_f32 v18, v96, v97
    ds_write_b32 v112, v18 offset:20992
    v_cvt_pk_f16_f32 v18, v98, v99
    ds_write_b32 v113, v18 offset:22016
    v_cvt_pk_f16_f32 v18, v100, v101
    ds_write_b32 v114, v18 offset:23040
    v_cvt_pk_f16_f32 v18, v102, v103
    ds_write_b32 v115, v18 offset:24064
    v_cvt_pk_f16_f32 v18, v104, v105
    ds_write_b32 v116, v18 offset:25088
    v_cvt_pk_f16_f32 v18, v106, v107
    ds_write_b32 v117, v18 offset:26112
    v_cvt_pk_f16_f32 v18, v108, v109
    ds_write_b32 v118, v18 offset:27136
    v_cvt_pk_f16_f32 v18, v110, v111
    ds_write_b32 v119, v18 offset:28160
    v_mul_f32 v16, v97, v65
    v_mul_f32 v17, v97, v64
    v_fma_f32 v2, v96, v64, -v16
    v_fma_f32 v3, v96, v65, v17
    v_cvt_pk_f16_f32 v18, v2, v3
    ds_write_b32 v120, v18 offset:29184
    v_mul_f32 v16, v99, v65
    v_mul_f32 v17, v99, v64
    v_fma_f32 v2, v98, v64, -v16
    v_fma_f32 v3, v98, v65, v17
    v_cvt_pk_f16_f32 v18, v2, v3
    ds_write_b32 v121, v18 offset:30208
    v_mul_f32 v16, v101, v65
    v_mul_f32 v17, v101, v64
    v_fma_f32 v2, v100, v64, -v16
    v_fma_f32 v3, v100, v65, v17
    v_cvt_pk_f16_f32 v18, v2, v3
    ds_write_b32 v122, v18 offset:31232
    v_mul_f32 v16, v103, v65
    v_mul_f32 v17, v103, v64
    v_fma_f32 v2, v102, v64, -v16
    v_fma_f32 v3, v102, v65, v17
    v_cvt_pk_f16_f32 v18, v2, v3
    ds_write_b32 v123, v18 offset:32256
    v_mul_f32 v16, v105, v65
    v_mul_f32 v17, v105, v64
    v_fma_f32 v2, v104, v64, -v16
    v_fma_f32 v3, v104, v65, v17
    v_cvt_pk_f16_f32 v18, v2, v3
    ds_write_b32 v124, v18 offset:33280
    v_mul_f32 v16, v107, v65
    v_mul_f32 v17, v107, v64
    v_fma_f32 v2, v106, v64, -v16
    v_fma_f32 v3, v106, v65, v17
    v_cvt_pk_f16_f32 v18, v2, v3
    ds_write_b32 v125, v18 offset:34304
    v_mul_f32 v16, v109, v65
    v_mul_f32 v17, v109, v64
    v_fma_f32 v2, v108, v64, -v16
    v_fma_f32 v3, v108, v65, v17
    v_cvt_pk_f16_f32 v18, v2, v3
    ds_write_b32 v126, v18 offset:35328
    v_mul_f32 v16, v111, v65
    v_mul_f32 v17, v111, v64
    v_fma_f32 v2, v110, v64, -v16
    v_fma_f32 v3, v110, v65, v17
    v_cvt_pk_f16_f32 v18, v2, v3
    ds_write_b32 v127, v18 offset:36352
    v_mul_f32 v16, v97, v67
    v_mul_f32 v17, v97, v66
    v_fma_f32 v2, v96, v66, -v16
    v_fma_f32 v3, v96, v67, v17
    v_cvt_pk_f16_f32 v18, v2, v3
    ds_write_b32 v112, v18 offset:37376
    v_mul_f32 v16, v101, v67
    v_mul_f32 v17, v101, v66
    v_fma_f32 v2, v100, v66, -v16
    v_fma_f32 v3, v100, v67, v17
    v_cvt_pk_f16_f32 v18, v2, v3
    ds_write_b32 v113, v18 offset:38400
    v_mul_f32 v16, v105, v67
    v_mul_f32 v17, v105, v66
    v_fma_f32 v2, v104, v66, -v16
    v_fma_f32 v3, v104, v67, v17
    v_cvt_pk_f16_f32 v18, v2, v3
    ds_write_b32 v114, v18 offset:39424
    v_mul_f32 v16, v109, v67
    v_mul_f32 v17, v109, v66
    v_fma_f32 v2, v108, v66, -v16
    v_fma_f32 v3, v108, v67, v17
    v_cvt_pk_f16_f32 v18, v2, v3
    ds_write_b32 v115, v18 offset:40448
    v_mul_f32 v16, v97, v69
    v_mul_f32 v17, v97, v68
    v_fma_f32 v2, v96, v68, -v16
    v_fma_f32 v3, v96, v69, v17
    v_cvt_pk_f16_f32 v18, v2, v3
    ds_write_b32 v116, v18 offset:41472
    v_mul_f32 v16, v101, v69
    v_mul_f32 v17, v101, v68
    v_fma_f32 v2, v100, v68, -v16
    v_fma_f32 v3, v100, v69, v17
    v_cvt_pk_f16_f32 v18, v2, v3
    ds_write_b32 v117, v18 offset:42496
    v_mul_f32 v16, v105, v69
    v_mul_f32 v17, v105, v68
    v_fma_f32 v2, v104, v68, -v16
    v_fma_f32 v3, v104, v69, v17
    v_cvt_pk_f16_f32 v18, v2, v3
    ds_write_b32 v118, v18 offset:43520
    v_mul_f32 v16, v109, v69
    v_mul_f32 v17, v109, v68
    v_fma_f32 v2, v108, v68, -v16
    v_fma_f32 v3, v108, v69, v17
    v_cvt_pk_f16_f32 v18, v2, v3
    ds_write_b32 v119, v18 offset:44544
    v_mul_f32 v16, v97, v71
    v_mul_f32 v17, v97, v70
    v_fma_f32 v2, v96, v70, -v16
    v_fma_f32 v3, v96, v71, v17
    v_cvt_pk_f16_f32 v18, v2, v3
    ds_write_b32 v120, v18 offset:45568
    v_mul_f32 v16, v105, v71
    v_mul_f32 v17, v105, v70
    v_fma_f32 v2, v104, v70, -v16
    v_fma_f32 v3, v104, v71, v17
    v_cvt_pk_f16_f32 v18, v2, v3
    ds_write_b32 v121, v18 offset:46592
    v_mul_f32 v16, v97, v73
    v_mul_f32 v17, v97, v72
    v_fma_f32 v2, v96, v72, -v16
    v_fma_f32 v3, v96, v73, v17
    v_cvt_pk_f16_f32 v18, v2, v3
    ds_write_b32 v122, v18 offset:47616
    v_mul_f32 v16, v105, v73
    v_mul_f32 v17, v105, v72
    v_fma_f32 v2, v104, v72, -v16
    v_fma_f32 v3, v104, v73, v17
    v_cvt_pk_f16_f32 v18, v2, v3
    ds_write_b32 v123, v18 offset:48640
    v_mul_f32 v16, v97, v75
    v_mul_f32 v17, v97, v74
    v_fma_f32 v2, v96, v74, -v16
    v_fma_f32 v3, v96, v75, v17
    v_cvt_pk_f16_f32 v18, v2, v3
    ds_write_b32 v124, v18 offset:49664
    v_mul_f32 v16, v105, v75
    v_mul_f32 v17, v105, v74
    v_fma_f32 v2, v104, v74, -v16
    v_fma_f32 v3, v104, v75, v17
    v_cvt_pk_f16_f32 v18, v2, v3
    ds_write_b32 v125, v18 offset:50688
    v_mul_f32 v16, v97, v77
    v_mul_f32 v17, v97, v76
    v_fma_f32 v2, v96, v76, -v16
    v_fma_f32 v3, v96, v77, v17
    v_cvt_pk_f16_f32 v18, v2, v3
    ds_write_b32 v126, v18 offset:51712
    v_mul_f32 v16, v105, v77
    v_mul_f32 v17, v105, v76
    v_fma_f32 v2, v104, v76, -v16
    v_fma_f32 v3, v104, v77, v17
    v_cvt_pk_f16_f32 v18, v2, v3
    ds_write_b32 v127, v18 offset:52736
    v_mul_f32 v16, v97, v79
    v_mul_f32 v17, v97, v78
    v_fma_f32 v2, v96, v78, -v16
    v_fma_f32 v3, v96, v79, v17
    v_cvt_pk_f16_f32 v18, v2, v3
    ds_write_b32 v112, v18 offset:53760
    v_mul_f32 v16, v97, v81
    v_mul_f32 v17, v97, v80
    v_fma_f32 v2, v96, v80, -v16
    v_fma_f32 v3, v96, v81, v17
    v_cvt_pk_f16_f32 v18, v2, v3
    ds_write_b32 v113, v18 offset:54784
    v_mul_f32 v16, v97, v83
    v_mul_f32 v17, v97, v82
    v_fma_f32 v2, v96, v82, -v16
    v_fma_f32 v3, v96, v83, v17
    v_cvt_pk_f16_f32 v18, v2, v3
    ds_write_b32 v114, v18 offset:55808
    v_mul_f32 v16, v97, v85
    v_mul_f32 v17, v97, v84
    v_fma_f32 v2, v96, v84, -v16
    v_fma_f32 v3, v96, v85, v17
    v_cvt_pk_f16_f32 v18, v2, v3
    ds_write_b32 v115, v18 offset:56832
    v_mul_f32 v16, v97, v87
    v_mul_f32 v17, v97, v86
    v_fma_f32 v2, v96, v86, -v16
    v_fma_f32 v3, v96, v87, v17
    v_cvt_pk_f16_f32 v18, v2, v3
    ds_write_b32 v116, v18 offset:57856
    v_mul_f32 v16, v97, v89
    v_mul_f32 v17, v97, v88
    v_fma_f32 v2, v96, v88, -v16
    v_fma_f32 v3, v96, v89, v17
    v_cvt_pk_f16_f32 v18, v2, v3
    ds_write_b32 v117, v18 offset:58880
    v_mul_f32 v16, v97, v91
    v_mul_f32 v17, v97, v90
    v_fma_f32 v2, v96, v90, -v16
    v_fma_f32 v3, v96, v91, v17
    v_cvt_pk_f16_f32 v18, v2, v3
    ds_write_b32 v118, v18 offset:59904
    v_mul_f32 v16, v97, v93
    v_mul_f32 v17, v97, v92
    v_fma_f32 v2, v96, v92, -v16
    v_fma_f32 v3, v96, v93, v17
    v_cvt_pk_f16_f32 v18, v2, v3
    ds_write_b32 v119, v18 offset:60928
    v_mul_f32 v16, v97, v95
    v_mul_f32 v17, v97, v94
    v_fma_f32 v2, v96, v94, -v16
    v_fma_f32 v3, v96, v95, v17
    v_cvt_pk_f16_f32 v18, v2, v3
    ds_write_b32 v120, v18 offset:61952
    v_cmp_eq_u32 vcc, 0, v0
    s_and_saveexec_b64 s[24:25], vcc
    s_lshl_b32 s26, s3, 2
    v_mov_b32 v14, s26
    s_add_u32 s28, s18, 16384
    s_addc_u32 s29, s19, 0
    global_store_dword v14, v15, s[28:29]
    s_mov_b64 exec, s[24:25]
    v_lshrrev_b32 v1, 6, v0
    v_and_b32 v2, 15, v0
    v_bfe_u32 v3, v0, 4, 2
    v_readfirstlane_b32 s23, v1
    v_xor_b32 v4, v3, v2
    s_waitcnt lgkmcnt(0)
    s_barrier
    s_cmp_eq_u32 s23, 3
    s_cbranch_scc1 K1_KG_SKIP
    v_lshlrev_b32 v5, 10, v2
    v_xor_b32 v6, 0, v4
    v_lshl_add_u32 v6, v6, 4, v5
    v_xor_b32 v7, 4, v4
    v_lshl_add_u32 v7, v7, 4, v5
    v_xor_b32 v8, 8, v4
    v_lshl_add_u32 v8, v8, 4, v5
    v_xor_b32 v9, 12, v4
    v_lshl_add_u32 v9, v9, 4, v5
    s_lshl_b32 s24, s23, 14
    s_add_u32 s24, s24, 20992
    v_add_u32 v10, s24, v6
    v_add_u32 v11, s24, v7
    v_add_u32 v12, s24, v8
    v_add_u32 v13, s24, v9
    v_mov_b32 v16, 0
    v_mov_b32 v17, 0
    v_mov_b32 v18, 0
    v_mov_b32 v19, 0
    ds_read_b128 v[32:35], v10 offset:0
    ds_read_b128 v[36:39], v6 offset:4608
    ds_read_b128 v[40:43], v11 offset:0
    ds_read_b128 v[44:47], v7 offset:4608
    ds_read_b128 v[48:51], v12 offset:0
    ds_read_b128 v[52:55], v8 offset:4608
    ds_read_b128 v[56:59], v13 offset:0
    ds_read_b128 v[60:63], v9 offset:4608
    ds_read_b128 v[64:67], v10 offset:256
    ds_read_b128 v[68:71], v6 offset:4864
    ds_read_b128 v[72:75], v11 offset:256
    ds_read_b128 v[76:79], v7 offset:4864
    ds_read_b128 v[80:83], v12 offset:256
    ds_read_b128 v[84:87], v8 offset:4864
    ds_read_b128 v[88:91], v13 offset:256
    ds_read_b128 v[92:95], v9 offset:4864
    s_waitcnt lgkmcnt(14)
    v_mfma_f32_16x16x32_f16 v[16:19], v[32:35], v[36:39], v[16:19]
    ds_read_b128 v[32:35], v10 offset:512
    ds_read_b128 v[36:39], v6 offset:5120
    s_waitcnt lgkmcnt(14)
    v_mfma_f32_16x16x32_f16 v[16:19], v[40:43], v[44:47], v[16:19]
    ds_read_b128 v[40:43], v11 offset:512
    ds_read_b128 v[44:47], v7 offset:5120
    s_waitcnt lgkmcnt(14)
    v_mfma_f32_16x16x32_f16 v[16:19], v[48:51], v[52:55], v[16:19]
    ds_read_b128 v[48:51], v12 offset:512
    ds_read_b128 v[52:55], v8 offset:5120
    s_waitcnt lgkmcnt(14)
    v_mfma_f32_16x16x32_f16 v[16:19], v[56:59], v[60:63], v[16:19]
    ds_read_b128 v[56:59], v13 offset:512
    ds_read_b128 v[60:63], v9 offset:5120
    s_waitcnt lgkmcnt(14)
    v_mfma_f32_16x16x32_f16 v[16:19], v[64:67], v[68:71], v[16:19]
    ds_read_b128 v[64:67], v10 offset:768
    ds_read_b128 v[68:71], v6 offset:5376
    s_waitcnt lgkmcnt(14)
    v_mfma_f32_16x16x32_f16 v[16:19], v[72:75], v[76:79], v[16:19]
    ds_read_b128 v[72:75], v11 offset:768
    ds_read_b128 v[76:79], v7 offset:5376
    s_waitcnt lgkmcnt(14)
    v_mfma_f32_16x16x32_f16 v[16:19], v[80:83], v[84:87], v[16:19]
    ds_read_b128 v[80:83], v12 offset:768
    ds_read_b128 v[84:87], v8 offset:5376
    s_waitcnt lgkmcnt(14)
    v_mfma_f32_16x16x32_f16 v[16:19], v[88:91], v[92:95], v[16:19]
    ds_read_b128 v[88:91], v13 offset:768
    ds_read_b128 v[92:95], v9 offset:5376
    s_waitcnt lgkmcnt(14)
    v_mfma_f32_16x16x32_f16 v[16:19], v[32:35], v[36:39], v[16:19]
    s_waitcnt lgkmcnt(12)
    v_mfma_f32_16x16x32_f16 v[16:19], v[40:43], v[44:47], v[16:19]
    s_waitcnt lgkmcnt(10)
    v_mfma_f32_16x16x32_f16 v[16:19], v[48:51], v[52:55], v[16:19]
    s_waitcnt lgkmcnt(8)
    v_mfma_f32_16x16x32_f16 v[16:19], v[56:59], v[60:63], v[16:19]
    s_waitcnt lgkmcnt(6)
    v_mfma_f32_16x16x32_f16 v[16:19], v[64:67], v[68:71], v[16:19]
    s_waitcnt lgkmcnt(4)
    v_mfma_f32_16x16x32_f16 v[16:19], v[72:75], v[76:79], v[16:19]
    s_waitcnt lgkmcnt(2)
    v_mfma_f32_16x16x32_f16 v[16:19], v[80:83], v[84:87], v[16:19]
    s_waitcnt lgkmcnt(0)
    v_mfma_f32_16x16x32_f16 v[16:19], v[88:91], v[92:95], v[16:19]
    v_lshlrev_b32 v20, 3, v2
    s_cmp_eq_u32 s23, 0
    s_cbranch_scc1 K1_KG_T0
    s_cmp_eq_u32 s23, 1
    s_cbranch_scc1 K1_KG_T1
    v_lshl_add_u32 v21, v3, 9, v20
    v_add_u32 v24, 1024, v21
    v_add_u32 v25, 1152, v21
    v_add_u32 v26, 1280, v21
    v_add_u32 v27, 1408, v21
    s_branch K1_KG_W
K1_KG_T0:
    v_and_b32 v21, 1, v3
    v_lshl_add_u32 v21, v21, 2, v20
    v_lshrrev_b32 v22, 1, v3
    v_lshl_add_u32 v21, v22, 7, v21
    v_add_u32 v24, 0, v21
    v_add_u32 v25, 1, v21
    v_add_u32 v26, 2, v21
    v_add_u32 v27, 3, v21
    s_branch K1_KG_W
K1_KG_T1:
    v_lshl_add_u32 v21, v3, 7, v20
    v_lshl_add_u32 v22, v3, 8, v20
    v_cmp_gt_u32 vcc, 2, v3
    v_add_u32 v28, 256, v21
    v_add_u32 v29, 0, v22
    v_cndmask_b32 v24, v29, v28, vcc
    v_add_u32 v28, 258, v21
    v_add_u32 v29, 4, v22
    v_cndmask_b32 v25, v29, v28, vcc
    v_add_u32 v28, 260, v21
    v_add_u32 v29, 128, v22
    v_cndmask_b32 v26, v29, v28, vcc
    v_add_u32 v28, 262, v21
    v_add_u32 v29, 132, v22
    v_cndmask_b32 v27, v29, v28, vcc
K1_KG_W:
    v_mov_b32 v28, 2056
    v_min_u32 v24, v24, v28
    v_lshlrev_b32 v24, 1, v24
    v_mul_f32 v16, 0x3b800000, v16
    v_cvt_f16_f32 v16, v16
    ds_write_b16 v24, v16 offset:0
    v_min_u32 v25, v25, v28
    v_lshlrev_b32 v25, 1, v25
    v_mul_f32 v17, 0x3b800000, v17
    v_cvt_f16_f32 v17, v17
    ds_write_b16 v25, v17 offset:0
    v_min_u32 v26, v26, v28
    v_lshlrev_b32 v26, 1, v26
    v_mul_f32 v18, 0x3b800000, v18
    v_cvt_f16_f32 v18, v18
    ds_write_b16 v26, v18 offset:0
    v_min_u32 v27, v27, v28
    v_lshlrev_b32 v27, 1, v27
    v_mul_f32 v19, 0x3b800000, v19
    v_cvt_f16_f32 v19, v19
    ds_write_b16 v27, v19 offset:0
K1_KG_SKIP:
    v_lshlrev_b32 v1, 3, v0
    v_add_u32 v2, 0, v1
    v_add_u32 v3, 1, v1
    v_cvt_f32_u32 v2, v2
    v_cvt_f32_u32 v3, v3
    v_cvt_pk_bf16_f32 v4, v2, v3
    v_lshlrev_b32 v2, 16, v4
    v_and_b32 v3, 0xffff0000, v4
    v_cvt_u32_f32 v2, v2
    v_cvt_u32_f32 v3, v3
    v_lshlrev_b32 v32, 1, v2
    v_lshlrev_b32 v33, 1, v3
    v_add_u32 v2, 2, v1
    v_add_u32 v3, 3, v1
    v_cvt_f32_u32 v2, v2
    v_cvt_f32_u32 v3, v3
    v_cvt_pk_bf16_f32 v4, v2, v3
    v_lshlrev_b32 v2, 16, v4
    v_and_b32 v3, 0xffff0000, v4
    v_cvt_u32_f32 v2, v2
    v_cvt_u32_f32 v3, v3
    v_lshlrev_b32 v34, 1, v2
    v_lshlrev_b32 v35, 1, v3
    v_add_u32 v2, 4, v1
    v_add_u32 v3, 5, v1
    v_cvt_f32_u32 v2, v2
    v_cvt_f32_u32 v3, v3
    v_cvt_pk_bf16_f32 v4, v2, v3
    v_lshlrev_b32 v2, 16, v4
    v_and_b32 v3, 0xffff0000, v4
    v_cvt_u32_f32 v2, v2
    v_cvt_u32_f32 v3, v3
    v_lshlrev_b32 v36, 1, v2
    v_lshlrev_b32 v37, 1, v3
    v_add_u32 v2, 6, v1
    v_add_u32 v3, 7, v1
    v_cvt_f32_u32 v2, v2
    v_cvt_f32_u32 v3, v3
    v_cvt_pk_bf16_f32 v4, v2, v3
    v_lshlrev_b32 v2, 16, v4
    v_and_b32 v3, 0xffff0000, v4
    v_cvt_u32_f32 v2, v2
    v_cvt_u32_f32 v3, v3
    v_lshlrev_b32 v38, 1, v2
    v_lshlrev_b32 v39, 1, v3
    s_lshl_b32 s24, s3, 12
    v_lshl_add_u32 v5, v0, 4, s24
    s_add_u32 s30, s18, 4194304
    s_addc_u32 s31, s19, 0
    s_waitcnt lgkmcnt(0)
    s_barrier
    ds_read_u16 v40, v32 offset:0
    ds_read_u16 v44, v33 offset:0
    ds_read_u16 v41, v34 offset:0
    ds_read_u16 v45, v35 offset:0
    ds_read_u16 v42, v36 offset:0
    ds_read_u16 v46, v37 offset:0
    ds_read_u16 v43, v38 offset:0
    ds_read_u16 v47, v39 offset:0
    s_waitcnt lgkmcnt(0)
    v_lshl_or_b32 v40, v44, 16, v40
    v_lshl_or_b32 v41, v45, 16, v41
    v_lshl_or_b32 v42, v46, 16, v42
    v_lshl_or_b32 v43, v47, 16, v43
    global_store_dwordx4 v5, v[40:43], s[30:31]
K1_END:
    s_endpgm
.globl conv_kernel
.p2align 8
.type conv_kernel,@function
conv_kernel:
    s_cmp_lt_u32 s2, 224
    s_cbranch_scc1 K2_CONV
    s_cmp_lt_u32 s2, 294
    s_cbranch_scc1 K2_PACK
    s_endpgm
K2_CONV:
    s_load_dwordx2 s[4:5], s[0:1], 144
    s_load_dwordx2 s[6:7], s[0:1], 64
    s_lshl_b32 s3, s2, 3
    s_lshl_b32 s16, s2, 2
    v_lshrrev_b32 v1, 2, v0
    v_mul_u32_u24 v1, 28672, v1
    v_and_b32 v2, 3, v0
    v_lshl_add_u32 v1, v2, 4, v1
    s_lshl_b32 s17, s2, 7
    v_add_u32 v1, s17, v1
    s_lshl_b32 s17, s2, 13
    v_lshl_add_u32 v2, v0, 4, s17
    v_add_u32 v7, 4096, v2
    s_waitcnt lgkmcnt(0)
    s_add_u32 s22, s3, 0
    s_load_dwordx2 s[8:9], s[4:5], s22
    s_add_u32 s22, s3, 12544
    s_load_dwordx2 s[10:11], s[4:5], s22
    s_add_u32 s22, s3, 3584
    s_load_dwordx2 s[12:13], s[4:5], s22
    s_add_u32 s22, s3, 16384
    s_load_dwordx2 s[14:15], s[4:5], s22
    s_load_dword s16, s[6:7], s16
    s_add_u32 s18, s4, 1048576
    s_addc_u32 s19, s5, 0
    s_add_u32 s20, s4, 4194304
    s_addc_u32 s21, s5, 0
    global_load_dwordx4 v[8:11], v1, s[18:19]
    global_load_dwordx4 v[12:15], v1, s[18:19] offset:64
    global_load_dwordx4 v[16:19], v2, s[20:21]
    global_load_dwordx4 v[20:23], v7, s[20:21]
    v_mov_b32 v24, 0
    v_mov_b32 v25, 0
    v_mov_b32 v26, 0
    v_mov_b32 v27, 0
    v_and_b32 v3, 31, v0
    v_lshlrev_b32 v3, 4, v3
    v_lshrrev_b32 v4, 5, v0
    v_mul_u32_u24 v4, 4608, v4
    v_add_u32 v3, v3, v4
    v_add_u32 v3, 69632, v3
    v_and_b32 v4, 7, v0
    v_mul_u32_u24 v5, 4352, v4
    v_and_b32 v6, 3, v4
    v_lshl_add_u32 v5, v6, 6, v5
    v_lshrrev_b32 v6, 2, v4
    v_lshl_add_u32 v5, v6, 5, v5
    v_bfe_u32 v6, v0, 3, 1
    v_mul_u32_u24 v6, 34816, v6
    v_add_u32 v5, v5, v6
    v_cmp_gt_u32 vcc, 64, v0
    s_and_saveexec_b64 s[24:25], vcc
    ds_write_b128 v3, v[24:27]
    v_cmp_gt_u32 vcc, 16, v0
    s_and_b64 exec, exec, vcc
    ds_write_b128 v5, v[24:27] offset:4096
    ds_write_b128 v5, v[24:27] offset:4112
    s_mov_b64 exec, s[24:25]
    v_lshlrev_b32 v3, 4, v0
    v_sub_u32 v4, 4080, v3
    v_add_u32 v5, 70144, v3
    v_and_b32 v100, 15, v0
    v_bfe_u32 v101, v0, 4, 2
    v_lshrrev_b32 v102, 6, v0
    s_nop 0
    v_readfirstlane_b32 s26, v102
    s_lshr_b32 s27, s26, 1
    s_and_b32 s28, s26, 1
    v_and_b32 v103, 7, v100
    v_sub_u32 v103, 7, v103
    v_mul_u32_u24 v104, 4352, v103
    v_and_b32 v105, 3, v103
    v_lshl_add_u32 v104, v105, 6, v104
    v_lshrrev_b32 v105, 2, v103
    v_lshl_add_u32 v104, v105, 5, v104
    v_and_b32 v105, 1, v101
    v_lshrrev_b32 v106, 1, v101
    v_lshlrev_b32 v106, 1, v106
    v_sub_u32 v105, v105, v106
    v_lshrrev_b32 v106, 3, v100
    v_sub_u32 v106, v105, v106
    v_add_u32 v106, 19, v106
    v_lshl_add_u32 v104, v106, 4, v104
    s_mul_i32 s29, s27, 34816
    s_lshl_b32 s30, s28, 8
    s_sub_u32 s29, s29, s30
    v_add_u32 v176, s29, v104
    v_lshlrev_b32 v106, 5, v100
    v_lshl_add_u32 v105, v105, 4, v106
    s_mul_i32 s29, s27, 4608
    s_add_u32 s29, s29, 69952
    s_sub_u32 s29, s29, s30
    v_add_u32 v177, s29, v105
    v_lshlrev_b32 v106, 6, v100
    v_lshl_add_u32 v106, v101, 4, v106
    s_mul_i32 s29, s27, 34816
    s_lshl_b32 s30, s28, 13
    s_add_u32 s29, s29, s30
    s_add_u32 s29, s29, 17408
    v_add_u32 v178, s29, v106
    v_lshlrev_b32 v107, 2, v102
    v_add_u32 v107, 78848, v107
    s_waitcnt vmcnt(3)
    v_lshlrev_b32 v44, 16, v8
    v_and_b32 v45, 0xffff0000, v8
    v_lshlrev_b32 v46, 16, v9
    v_and_b32 v47, 0xffff0000, v9
    v_lshlrev_b32 v48, 16, v10
    v_and_b32 v49, 0xffff0000, v10
    v_lshlrev_b32 v50, 16, v11
    v_and_b32 v51, 0xffff0000, v11
    v_cvt_pk_f16_f32 v52, v51, v50
    v_cvt_pk_f16_f32 v53, v49, v48
    v_cvt_pk_f16_f32 v54, v47, v46
    v_cvt_pk_f16_f32 v55, v45, v44
    v_mov_b32 v188, v8
    v_mov_b32 v189, v9
    v_mov_b32 v190, v10
    v_mov_b32 v191, v11
    ds_write_b128 v4, v[52:55] offset:0
    s_waitcnt vmcnt(2)
    v_lshlrev_b32 v44, 16, v12
    v_and_b32 v45, 0xffff0000, v12
    v_lshlrev_b32 v46, 16, v13
    v_and_b32 v47, 0xffff0000, v13
    v_lshlrev_b32 v48, 16, v14
    v_and_b32 v49, 0xffff0000, v14
    v_lshlrev_b32 v50, 16, v15
    v_and_b32 v51, 0xffff0000, v15
    v_cvt_pk_f16_f32 v52, v51, v50
    v_cvt_pk_f16_f32 v53, v49, v48
    v_cvt_pk_f16_f32 v54, v47, v46
    v_cvt_pk_f16_f32 v55, v45, v44
    v_mov_b32 v192, v12
    v_mov_b32 v193, v13
    v_mov_b32 v194, v14
    v_mov_b32 v195, v15
    ds_write_b128 v4, v[52:55] offset:34816
    s_waitcnt vmcnt(0)
    ds_write_b128 v5, v[16:19]
    ds_write_b128 v5, v[20:23] offset:4608
    v_cvt_f32_f16 v196, v16
    v_cvt_f32_f16_sdwa v197, v16 src0_sel:WORD_1
    v_cvt_f32_f16 v198, v17
    v_cvt_f32_f16_sdwa v199, v17 src0_sel:WORD_1
    v_cvt_f32_f16 v200, v18
    v_cvt_f32_f16_sdwa v201, v18 src0_sel:WORD_1
    v_cvt_f32_f16 v202, v19
    v_cvt_f32_f16_sdwa v203, v19 src0_sel:WORD_1
    v_cvt_f32_f16 v204, v20
    v_cvt_f32_f16_sdwa v205, v20 src0_sel:WORD_1
    v_cvt_f32_f16 v206, v21
    v_cvt_f32_f16_sdwa v207, v21 src0_sel:WORD_1
    v_cvt_f32_f16 v208, v22
    v_cvt_f32_f16_sdwa v209, v22 src0_sel:WORD_1
    v_cvt_f32_f16 v210, v23
    v_cvt_f32_f16_sdwa v211, v23 src0_sel:WORD_1
    v_add_f32 v197, v197, v196
    v_add_f32 v205, v205, v204
    v_add_f32 v198, v198, v197
    v_add_f32 v206, v206, v205
    v_add_f32 v199, v199, v198
    v_add_f32 v207, v207, v206
    v_add_f32 v200, v200, v199
    v_add_f32 v208, v208, v207
    v_add_f32 v201, v201, v200
    v_add_f32 v209, v209, v208
    v_add_f32 v202, v202, v201
    v_add_f32 v210, v210, v209
    v_add_f32 v203, v203, v202
    v_add_f32 v211, v211, v210
    v_mov_b32 v44, v203
    v_mov_b32 v45, v211
    s_nop 0
    v_add_f32_dpp v44, v44, v44 row_shr:1 row_mask:0xf bank_mask:0xf bound_ctrl:0
    v_add_f32_dpp v45, v45, v45 row_shr:1 row_mask:0xf bank_mask:0xf bound_ctrl:0
    s_nop 0
    v_add_f32_dpp v44, v44, v44 row_shr:2 row_mask:0xf bank_mask:0xf bound_ctrl:0
    v_add_f32_dpp v45, v45, v45 row_shr:2 row_mask:0xf bank_mask:0xf bound_ctrl:0
    s_nop 0
    v_add_f32_dpp v44, v44, v44 row_shr:4 row_mask:0xf bank_mask:0xf bound_ctrl:0
    v_add_f32_dpp v45, v45, v45 row_shr:4 row_mask:0xf bank_mask:0xf bound_ctrl:0
    s_nop 0
    v_add_f32_dpp v44, v44, v44 row_shr:8 row_mask:0xf bank_mask:0xf bound_ctrl:0
    v_add_f32_dpp v45, v45, v45 row_shr:8 row_mask:0xf bank_mask:0xf bound_ctrl:0
    s_nop 0
    v_add_f32_dpp v44, v44, v44 row_bcast:15 row_mask:0xa bank_mask:0xf
    v_add_f32_dpp v45, v45, v45 row_bcast:15 row_mask:0xa bank_mask:0xf
    s_nop 0
    v_add_f32_dpp v44, v44, v44 row_bcast:31 row_mask:0xc bank_mask:0xf
    v_add_f32_dpp v45, v45, v45 row_bcast:31 row_mask:0xc bank_mask:0xf
    v_sub_f32 v212, v44, v203
    v_sub_f32 v213, v45, v211
    v_and_b32 v46, 63, v0
    v_cmp_eq_u32 vcc, 63, v46
    s_and_saveexec_b64 s[24:25], vcc
    ds_write_b32 v107, v44
    ds_write_b32 v107, v45 offset:16
    s_mov_b64 exec, s[24:25]
    s_waitcnt lgkmcnt(0)
    s_barrier
    ds_read_b128 v[44:47], v3 offset:0
    ds_read_b128 v[48:51], v3 offset:16
    ds_read_b128 v[52:55], v3 offset:34816
    ds_read_b128 v[56:59], v3 offset:34832
    v_mov_b32 v107, 78848
    ds_read_b128 v[216:219], v107
    ds_read_b128 v[220:223], v107 offset:16
    s_waitcnt lgkmcnt(4)
    v_mov_b32 v60, v45
    v_mov_b32 v61, v46
    v_mov_b32 v62, v47
    v_mov_b32 v63, v48
    v_mov_b32 v64, v49
    v_mov_b32 v65, v50
    v_alignbit_b32 v66, v45, v44, 16
    v_alignbit_b32 v67, v46, v45, 16
    v_alignbit_b32 v68, v47, v46, 16
    v_alignbit_b32 v69, v48, v47, 16
    v_alignbit_b32 v70, v49, v48, 16
    v_alignbit_b32 v71, v50, v49, 16
    v_alignbit_b32 v72, v46, v45, 16
    v_alignbit_b32 v73, v47, v46, 16
    v_alignbit_b32 v74, v48, v47, 16
    v_alignbit_b32 v75, v49, v48, 16
    v_alignbit_b32 v76, v50, v49, 16
    v_alignbit_b32 v77, v51, v50, 16
    ds_write_b128 v3, v[66:69] offset:4416
    ds_write_b128 v3, v[60:63] offset:8832
    ds_write_b128 v3, v[72:75] offset:13248
    ds_write_b128 v3, v[46:49] offset:17440
    ds_write_b128 v3, v[68:71] offset:21856
    ds_write_b128 v3, v[62:65] offset:26272
    ds_write_b128 v3, v[74:77] offset:30688
    s_waitcnt lgkmcnt(7)
    v_mov_b32 v78, v53
    v_mov_b32 v79, v54
    v_mov_b32 v80, v55
    v_mov_b32 v81, v56
    v_mov_b32 v82, v57
    v_mov_b32 v83, v58
    v_alignbit_b32 v84, v53, v52, 16
    v_alignbit_b32 v85, v54, v53, 16
    v_alignbit_b32 v86, v55, v54, 16
    v_alignbit_b32 v87, v56, v55, 16
    v_alignbit_b32 v88, v57, v56, 16
    v_alignbit_b32 v89, v58, v57, 16
    v_alignbit_b32 v90, v54, v53, 16
    v_alignbit_b32 v91, v55, v54, 16
    v_alignbit_b32 v92, v56, v55, 16
    v_alignbit_b32 v93, v57, v56, 16
    v_alignbit_b32 v94, v58, v57, 16
    v_alignbit_b32 v95, v59, v58, 16
    ds_write_b128 v3, v[84:87] offset:39232
    ds_write_b128 v3, v[78:81] offset:43648
    ds_write_b128 v3, v[90:93] offset:48064
    ds_write_b128 v3, v[54:57] offset:52256
    ds_write_b128 v3, v[86:89] offset:56672
    ds_write_b128 v3, v[80:83] offset:61088
    ds_write_b128 v3, v[92:95] offset:65504
    s_cmp_gt_u32 s26, 0
    s_cselect_b32 s29, 1.0, 0
    v_fma_f32 v212, v216, s29, v212
    v_fma_f32 v213, v220, s29, v213
    s_cmp_gt_u32 s26, 1
    s_cselect_b32 s29, 1.0, 0
    v_fma_f32 v212, v217, s29, v212
    v_fma_f32 v213, v221, s29, v213
    s_cmp_gt_u32 s26, 2
    s_cselect_b32 s29, 1.0, 0
    v_fma_f32 v212, v218, s29, v212
    v_fma_f32 v213, v222, s29, v213
    v_lshlrev_b32 v184, 5, v0
    s_lshl_b32 s29, s2, 13
    v_lshl_add_u32 v186, v0, 4, s29
    v_add_u32 v187, 4096, v186
    s_waitcnt lgkmcnt(0)
    s_barrier
    ds_read_b128 v[48:51], v176 offset:3776
    ds_read_b128 v[80:83], v177 offset:192
    ds_read_b128 v[52:55], v176 offset:3264
    ds_read_b128 v[84:87], v177 offset:704
    ds_read_b128 v[56:59], v176 offset:2752
    ds_read_b128 v[88:91], v177 offset:1216
    ds_read_b128 v[60:63], v176 offset:2240
    ds_read_b128 v[92:95], v177 offset:1728
    ds_read_b128 v[64:67], v176 offset:1728
    ds_read_b128 v[96:99], v177 offset:2240
    ds_read_b128 v[68:71], v176 offset:1216
    ds_read_b128 v[100:103], v177 offset:2752
    ds_read_b128 v[72:75], v176 offset:704
    ds_read_b128 v[104:107], v177 offset:3264
    ds_read_b128 v[76:79], v176 offset:192
    ds_read_b128 v[108:111], v177 offset:3776
    v_mov_b32 v8, 0
    v_mov_b32 v9, 0
    v_mov_b32 v10, 0
    v_mov_b32 v11, 0
    v_mov_b32 v12, 0
    v_mov_b32 v13, 0
    v_mov_b32 v14, 0
    v_mov_b32 v15, 0
    v_mov_b32 v16, 0
    v_mov_b32 v17, 0
    v_mov_b32 v18, 0
    v_mov_b32 v19, 0
    v_mov_b32 v20, 0
    v_mov_b32 v21, 0
    v_mov_b32 v22, 0
    v_mov_b32 v23, 0
    v_mov_b32 v24, 0
    v_mov_b32 v25, 0
    v_mov_b32 v26, 0
    v_mov_b32 v27, 0
    v_mov_b32 v28, 0
    v_mov_b32 v29, 0
    v_mov_b32 v30, 0
    v_mov_b32 v31, 0
    v_mov_b32 v32, 0
    v_mov_b32 v33, 0
    v_mov_b32 v34, 0
    v_mov_b32 v35, 0
    v_mov_b32 v36, 0
    v_mov_b32 v37, 0
    v_mov_b32 v38, 0
    v_mov_b32 v39, 0
    s_waitcnt lgkmcnt(14)
    v_mfma_f32_16x16x32_f16 v[8:11], v[48:51], v[80:83], v[8:11]
    s_waitcnt lgkmcnt(12)
    v_mfma_f32_16x16x32_f16 v[12:15], v[48:51], v[84:87], v[12:15]
    v_mfma_f32_16x16x32_f16 v[16:19], v[52:55], v[84:87], v[16:19]
    v_mfma_f32_16x16x32_f16 v[12:15], v[52:55], v[80:83], v[12:15]
    s_waitcnt lgkmcnt(10)
    v_mfma_f32_16x16x32_f16 v[16:19], v[48:51], v[88:91], v[16:19]
    v_mfma_f32_16x16x32_f16 v[20:23], v[52:55], v[88:91], v[20:23]
    v_mfma_f32_16x16x32_f16 v[24:27], v[56:59], v[88:91], v[24:27]
    v_mfma_f32_16x16x32_f16 v[16:19], v[56:59], v[80:83], v[16:19]
    v_mfma_f32_16x16x32_f16 v[20:23], v[56:59], v[84:87], v[20:23]
    s_waitcnt lgkmcnt(8)
    v_mfma_f32_16x16x32_f16 v[20:23], v[48:51], v[92:95], v[20:23]
    v_mfma_f32_16x16x32_f16 v[24:27], v[52:55], v[92:95], v[24:27]
    v_mfma_f32_16x16x32_f16 v[28:31], v[56:59], v[92:95], v[28:31]
    v_mfma_f32_16x16x32_f16 v[20:23], v[60:63], v[80:83], v[20:23]
    v_mfma_f32_16x16x32_f16 v[24:27], v[60:63], v[84:87], v[24:27]
    v_mfma_f32_16x16x32_f16 v[28:31], v[60:63], v[88:91], v[28:31]
    v_mfma_f32_16x16x32_f16 v[32:35], v[60:63], v[92:95], v[32:35]
    s_waitcnt lgkmcnt(6)
    v_mfma_f32_16x16x32_f16 v[24:27], v[48:51], v[96:99], v[24:27]
    v_mfma_f32_16x16x32_f16 v[28:31], v[52:55], v[96:99], v[28:31]
    v_mfma_f32_16x16x32_f16 v[32:35], v[56:59], v[96:99], v[32:35]
    v_mfma_f32_16x16x32_f16 v[36:39], v[60:63], v[96:99], v[36:39]
    v_mfma_f32_16x16x32_f16 v[24:27], v[64:67], v[80:83], v[24:27]
    v_mfma_f32_16x16x32_f16 v[28:31], v[64:67], v[84:87], v[28:31]
    v_mfma_f32_16x16x32_f16 v[32:35], v[64:67], v[88:91], v[32:35]
    v_mfma_f32_16x16x32_f16 v[36:39], v[64:67], v[92:95], v[36:39]
    s_waitcnt lgkmcnt(4)
    v_mfma_f32_16x16x32_f16 v[28:31], v[48:51], v[100:103], v[28:31]
    v_mfma_f32_16x16x32_f16 v[32:35], v[52:55], v[100:103], v[32:35]
    v_mfma_f32_16x16x32_f16 v[36:39], v[56:59], v[100:103], v[36:39]
    v_mfma_f32_16x16x32_f16 v[28:31], v[68:71], v[80:83], v[28:31]
    v_mfma_f32_16x16x32_f16 v[32:35], v[68:71], v[84:87], v[32:35]
    v_mfma_f32_16x16x32_f16 v[36:39], v[68:71], v[88:91], v[36:39]
    s_waitcnt lgkmcnt(2)
    v_mfma_f32_16x16x32_f16 v[32:35], v[48:51], v[104:107], v[32:35]
    v_mfma_f32_16x16x32_f16 v[36:39], v[52:55], v[104:107], v[36:39]
    v_mfma_f32_16x16x32_f16 v[32:35], v[72:75], v[80:83], v[32:35]
    v_mfma_f32_16x16x32_f16 v[36:39], v[72:75], v[84:87], v[36:39]
    s_waitcnt lgkmcnt(0)
    v_mfma_f32_16x16x32_f16 v[36:39], v[48:51], v[108:111], v[36:39]
    ds_read_b128 v[112:115], v176 offset:3712
    ds_read_b128 v[144:147], v177 offset:128
    v_mfma_f32_16x16x32_f16 v[36:39], v[76:79], v[80:83], v[36:39]
    ds_read_b128 v[116:119], v176 offset:3200
    ds_read_b128 v[148:151], v177 offset:640
    ds_read_b128 v[120:123], v176 offset:2688
    ds_read_b128 v[152:155], v177 offset:1152
    ds_read_b128 v[124:127], v176 offset:2176
    ds_read_b128 v[156:159], v177 offset:1664
    ds_read_b128 v[128:131], v176 offset:1664
    ds_read_b128 v[160:163], v177 offset:2176
    ds_read_b128 v[132:135], v176 offset:1152
    ds_read_b128 v[164:167], v177 offset:2688
    ds_read_b128 v[136:139], v176 offset:640
    ds_read_b128 v[168:171], v177 offset:3200
    ds_read_b128 v[140:143], v176 offset:128
    ds_read_b128 v[172:175], v177 offset:3712
    s_waitcnt lgkmcnt(0)
    v_mfma_f32_16x16x32_f16 v[8:11], v[112:115], v[144:147], v[8:11]
    v_mov_b32 v224, s10
    v_mov_b32 v226, s8
    ds_read_b128 v[48:51], v176 offset:3648
    ds_read_b128 v[80:83], v177 offset:64
    v_mfma_f32_16x16x32_f16 v[12:15], v[112:115], v[148:151], v[12:15]
    v_mov_b32 v46, s14
    v_mul_f32 v46, s12, v46
    ds_read_b128 v[52:55], v176 offset:3136
    ds_read_b128 v[84:87], v177 offset:576
    v_mfma_f32_16x16x32_f16 v[16:19], v[112:115], v[152:155], v[16:19]
    v_mul_f32 v228, v46, v224
    v_mov_b32 v229, v228
    ds_read_b128 v[56:59], v176 offset:2624
    ds_read_b128 v[88:91], v177 offset:1088
    v_mfma_f32_16x16x32_f16 v[20:23], v[112:115], v[156:159], v[20:23]
    v_mul_f32 v230, v46, v226
    v_mov_b32 v46, s16
    ds_read_b128 v[60:63], v176 offset:2112
    ds_read_b128 v[92:95], v177 offset:1600
    v_mfma_f32_16x16x32_f16 v[24:27], v[112:115], v[160:163], v[24:27]
    v_lshlrev_b32 v46, 16, v46
    v_mul_f32 v231, s12, v46
    ds_read_b128 v[64:67], v176 offset:1600
    ds_read_b128 v[96:99], v177 offset:2112
    v_mfma_f32_16x16x32_f16 v[28:31], v[112:115], v[164:167], v[28:31]
    v_lshlrev_b32 v240, 16, v188
    v_and_b32 v241, 0xffff0000, v188
    ds_read_b128 v[68:71], v176 offset:1088
    ds_read_b128 v[100:103], v177 offset:2624
    v_mfma_f32_16x16x32_f16 v[32:35], v[112:115], v[168:171], v[32:35]
    v_lshlrev_b32 v242, 16, v189
    v_and_b32 v243, 0xffff0000, v189
    ds_read_b128 v[72:75], v176 offset:576
    ds_read_b128 v[104:107], v177 offset:3136
    v_mfma_f32_16x16x32_f16 v[36:39], v[112:115], v[172:175], v[36:39]
    v_lshlrev_b32 v244, 16, v190
    v_and_b32 v245, 0xffff0000, v190
    ds_read_b128 v[76:79], v176 offset:64
    ds_read_b128 v[108:111], v177 offset:3648
    v_mfma_f32_16x16x32_f16 v[12:15], v[116:119], v[144:147], v[12:15]
    v_lshlrev_b32 v246, 16, v191
    v_and_b32 v247, 0xffff0000, v191
    v_mfma_f32_16x16x32_f16 v[16:19], v[116:119], v[148:151], v[16:19]
    v_fma_f32 v240, v240, v224, v226
    v_fma_f32 v241, v241, v224, v226
    v_mfma_f32_16x16x32_f16 v[20:23], v[116:119], v[152:155], v[20:23]
    v_fma_f32 v242, v242, v224, v226
    v_fma_f32 v243, v243, v224, v226
    v_mfma_f32_16x16x32_f16 v[24:27], v[116:119], v[156:159], v[24:27]
    v_fma_f32 v244, v244, v224, v226
    v_fma_f32 v245, v245, v224, v226
    v_mfma_f32_16x16x32_f16 v[28:31], v[116:119], v[160:163], v[28:31]
    v_fma_f32 v246, v246, v224, v226
    v_fma_f32 v247, v247, v224, v226
    v_mfma_f32_16x16x32_f16 v[32:35], v[116:119], v[164:167], v[32:35]
    v_cvt_pk_bf16_f32 v40, v240, v241
    v_cvt_pk_bf16_f32 v41, v242, v243
    v_mfma_f32_16x16x32_f16 v[36:39], v[116:119], v[168:171], v[36:39]
    v_cvt_pk_bf16_f32 v42, v244, v245
    v_cvt_pk_bf16_f32 v43, v246, v247
    v_mfma_f32_16x16x32_f16 v[16:19], v[120:123], v[144:147], v[16:19]
    v_lshlrev_b32 v240, 16, v40
    v_and_b32 v241, 0xffff0000, v40
    v_mfma_f32_16x16x32_f16 v[20:23], v[120:123], v[148:151], v[20:23]
    v_lshlrev_b32 v242, 16, v41
    v_and_b32 v243, 0xffff0000, v41
    v_mfma_f32_16x16x32_f16 v[24:27], v[120:123], v[152:155], v[24:27]
    v_lshlrev_b32 v244, 16, v42
    v_and_b32 v245, 0xffff0000, v42
    v_mfma_f32_16x16x32_f16 v[28:31], v[120:123], v[156:159], v[28:31]
    v_lshlrev_b32 v246, 16, v43
    v_and_b32 v247, 0xffff0000, v43
    v_mfma_f32_16x16x32_f16 v[32:35], v[120:123], v[160:163], v[32:35]
    v_mul_f32 v46, v230, v212
    v_fma_f32 v240, v240, v231, v46
    v_mfma_f32_16x16x32_f16 v[36:39], v[120:123], v[164:167], v[36:39]
    v_fma_f32 v241, v241, v231, v46
    v_fma_f32 v242, v242, v231, v46
    v_mfma_f32_16x16x32_f16 v[20:23], v[124:127], v[144:147], v[20:23]
    v_fma_f32 v243, v243, v231, v46
    v_fma_f32 v244, v244, v231, v46
    v_mfma_f32_16x16x32_f16 v[24:27], v[124:127], v[148:151], v[24:27]
    v_fma_f32 v245, v245, v231, v46
    v_fma_f32 v246, v246, v231, v46
    v_mfma_f32_16x16x32_f16 v[28:31], v[124:127], v[152:155], v[28:31]
    v_fma_f32 v247, v247, v231, v46
    v_fma_f32 v240, v196, v230, v240
    v_mfma_f32_16x16x32_f16 v[32:35], v[124:127], v[156:159], v[32:35]
    v_fma_f32 v241, v197, v230, v241
    v_fma_f32 v242, v198, v230, v242
    v_mfma_f32_16x16x32_f16 v[36:39], v[124:127], v[160:163], v[36:39]
    v_fma_f32 v243, v199, v230, v243
    v_fma_f32 v244, v200, v230, v244
    v_mfma_f32_16x16x32_f16 v[24:27], v[128:131], v[144:147], v[24:27]
    v_fma_f32 v245, v201, v230, v245
    v_fma_f32 v246, v202, v230, v246
    v_mfma_f32_16x16x32_f16 v[28:31], v[128:131], v[148:151], v[28:31]
    v_fma_f32 v247, v203, v230, v247
    v_mov_b32 v232, s11
    v_mfma_f32_16x16x32_f16 v[32:35], v[128:131], v[152:155], v[32:35]
    v_mov_b32 v234, s9
    v_mov_b32 v46, s15
    v_mfma_f32_16x16x32_f16 v[36:39], v[128:131], v[156:159], v[36:39]
    v_mul_f32 v46, s13, v46
    v_mul_f32 v236, v46, v232
    v_mfma_f32_16x16x32_f16 v[28:31], v[132:135], v[144:147], v[28:31]
    v_mov_b32 v237, v236
    v_mul_f32 v238, v46, v234
    v_mfma_f32_16x16x32_f16 v[32:35], v[132:135], v[148:151], v[32:35]
    v_mov_b32 v46, s16
    v_and_b32 v46, 0xffff0000, v46
    v_mfma_f32_16x16x32_f16 v[36:39], v[132:135], v[152:155], v[36:39]
    v_mul_f32 v239, s13, v46
    v_lshlrev_b32 v248, 16, v192
    v_mfma_f32_16x16x32_f16 v[32:35], v[136:139], v[144:147], v[32:35]
    v_and_b32 v249, 0xffff0000, v192
    v_lshlrev_b32 v250, 16, v193
    v_mfma_f32_16x16x32_f16 v[36:39], v[136:139], v[148:151], v[36:39]
    v_and_b32 v251, 0xffff0000, v193
    v_lshlrev_b32 v252, 16, v194
    v_mfma_f32_16x16x32_f16 v[36:39], v[140:143], v[144:147], v[36:39]
    v_and_b32 v253, 0xffff0000, v194
    v_lshlrev_b32 v254, 16, v195
    s_waitcnt lgkmcnt(0)
    v_mfma_f32_16x16x32_f16 v[8:11], v[48:51], v[80:83], v[8:11]
    v_and_b32 v255, 0xffff0000, v195
    v_fma_f32 v248, v248, v232, v234
    ds_read_b128 v[112:115], v176 offset:3584
    ds_read_b128 v[144:147], v177 offset:0
    v_mfma_f32_16x16x32_f16 v[12:15], v[48:51], v[84:87], v[12:15]
    v_fma_f32 v249, v249, v232, v234
    v_fma_f32 v250, v250, v232, v234
    ds_read_b128 v[116:119], v176 offset:3072
    ds_read_b128 v[148:151], v177 offset:512
    v_mfma_f32_16x16x32_f16 v[16:19], v[48:51], v[88:91], v[16:19]
    v_fma_f32 v251, v251, v232, v234
    v_fma_f32 v252, v252, v232, v234
    ds_read_b128 v[120:123], v176 offset:2560
    ds_read_b128 v[152:155], v177 offset:1024
    v_mfma_f32_16x16x32_f16 v[20:23], v[48:51], v[92:95], v[20:23]
    v_fma_f32 v253, v253, v232, v234
    v_fma_f32 v254, v254, v232, v234
    ds_read_b128 v[124:127], v176 offset:2048
    ds_read_b128 v[156:159], v177 offset:1536
    v_mfma_f32_16x16x32_f16 v[24:27], v[48:51], v[96:99], v[24:27]
    v_fma_f32 v255, v255, v232, v234
    v_cvt_pk_bf16_f32 v40, v248, v249
    ds_read_b128 v[128:131], v176 offset:1536
    ds_read_b128 v[160:163], v177 offset:2048
    v_mfma_f32_16x16x32_f16 v[28:31], v[48:51], v[100:103], v[28:31]
    v_cvt_pk_bf16_f32 v41, v250, v251
    v_cvt_pk_bf16_f32 v42, v252, v253
    ds_read_b128 v[132:135], v176 offset:1024
    ds_read_b128 v[164:167], v177 offset:2560
    v_mfma_f32_16x16x32_f16 v[32:35], v[48:51], v[104:107], v[32:35]
    v_cvt_pk_bf16_f32 v43, v254, v255
    v_lshlrev_b32 v248, 16, v40
    ds_read_b128 v[136:139], v176 offset:512
    ds_read_b128 v[168:171], v177 offset:3072
    v_mfma_f32_16x16x32_f16 v[36:39], v[48:51], v[108:111], v[36:39]
    v_and_b32 v249, 0xffff0000, v40
    v_lshlrev_b32 v250, 16, v41
    ds_read_b128 v[140:143], v176 offset:0
    ds_read_b128 v[172:175], v177 offset:3584
    v_mfma_f32_16x16x32_f16 v[12:15], v[52:55], v[80:83], v[12:15]
    v_and_b32 v251, 0xffff0000, v41
    v_lshlrev_b32 v252, 16, v42
    v_mfma_f32_16x16x32_f16 v[16:19], v[52:55], v[84:87], v[16:19]
    v_and_b32 v253, 0xffff0000, v42
    v_lshlrev_b32 v254, 16, v43
    v_mfma_f32_16x16x32_f16 v[20:23], v[52:55], v[88:91], v[20:23]
    v_and_b32 v255, 0xffff0000, v43
    v_mul_f32 v46, v238, v213
    v_mfma_f32_16x16x32_f16 v[24:27], v[52:55], v[92:95], v[24:27]
    v_fma_f32 v248, v248, v239, v46
    v_fma_f32 v249, v249, v239, v46
    v_mfma_f32_16x16x32_f16 v[28:31], v[52:55], v[96:99], v[28:31]
    v_fma_f32 v250, v250, v239, v46
    v_fma_f32 v251, v251, v239, v46
    v_mfma_f32_16x16x32_f16 v[32:35], v[52:55], v[100:103], v[32:35]
    v_fma_f32 v252, v252, v239, v46
    v_fma_f32 v253, v253, v239, v46
    v_mfma_f32_16x16x32_f16 v[36:39], v[52:55], v[104:107], v[36:39]
    v_fma_f32 v254, v254, v239, v46
    v_fma_f32 v255, v255, v239, v46
    v_mfma_f32_16x16x32_f16 v[16:19], v[56:59], v[80:83], v[16:19]
    v_fma_f32 v248, v204, v238, v248
    v_fma_f32 v249, v205, v238, v249
    v_mfma_f32_16x16x32_f16 v[20:23], v[56:59], v[84:87], v[20:23]
    v_fma_f32 v250, v206, v238, v250
    v_fma_f32 v251, v207, v238, v251
    v_mfma_f32_16x16x32_f16 v[24:27], v[56:59], v[88:91], v[24:27]
    v_fma_f32 v252, v208, v238, v252
    v_fma_f32 v253, v209, v238, v253
    v_mfma_f32_16x16x32_f16 v[28:31], v[56:59], v[92:95], v[28:31]
    v_fma_f32 v254, v210, v238, v254
    v_fma_f32 v255, v211, v238, v255
    v_mfma_f32_16x16x32_f16 v[32:35], v[56:59], v[96:99], v[32:35]
    v_mfma_f32_16x16x32_f16 v[36:39], v[56:59], v[100:103], v[36:39]
    v_mfma_f32_16x16x32_f16 v[20:23], v[60:63], v[80:83], v[20:23]
    v_mfma_f32_16x16x32_f16 v[24:27], v[60:63], v[84:87], v[24:27]
    v_mfma_f32_16x16x32_f16 v[28:31], v[60:63], v[88:91], v[28:31]
    v_mfma_f32_16x16x32_f16 v[32:35], v[60:63], v[92:95], v[32:35]
    v_mfma_f32_16x16x32_f16 v[36:39], v[60:63], v[96:99], v[36:39]
    v_mfma_f32_16x16x32_f16 v[24:27], v[64:67], v[80:83], v[24:27]
    v_mfma_f32_16x16x32_f16 v[28:31], v[64:67], v[84:87], v[28:31]
    v_mfma_f32_16x16x32_f16 v[32:35], v[64:67], v[88:91], v[32:35]
    v_mfma_f32_16x16x32_f16 v[36:39], v[64:67], v[92:95], v[36:39]
    v_mfma_f32_16x16x32_f16 v[28:31], v[68:71], v[80:83], v[28:31]
    v_mfma_f32_16x16x32_f16 v[32:35], v[68:71], v[84:87], v[32:35]
    v_mfma_f32_16x16x32_f16 v[36:39], v[68:71], v[88:91], v[36:39]
    v_mfma_f32_16x16x32_f16 v[32:35], v[72:75], v[80:83], v[32:35]
    v_mfma_f32_16x16x32_f16 v[36:39], v[72:75], v[84:87], v[36:39]
    v_mfma_f32_16x16x32_f16 v[36:39], v[76:79], v[80:83], v[36:39]
    s_waitcnt lgkmcnt(0)
    v_mfma_f32_16x16x32_f16 v[8:11], v[112:115], v[144:147], v[8:11]
    v_mfma_f32_16x16x32_f16 v[12:15], v[112:115], v[148:151], v[12:15]
    v_mfma_f32_16x16x32_f16 v[16:19], v[112:115], v[152:155], v[16:19]
    v_mfma_f32_16x16x32_f16 v[20:23], v[112:115], v[156:159], v[20:23]
    v_mfma_f32_16x16x32_f16 v[24:27], v[112:115], v[160:163], v[24:27]
    v_mfma_f32_16x16x32_f16 v[28:31], v[112:115], v[164:167], v[28:31]
    v_mfma_f32_16x16x32_f16 v[32:35], v[112:115], v[168:171], v[32:35]
    v_mfma_f32_16x16x32_f16 v[36:39], v[112:115], v[172:175], v[36:39]
    v_mfma_f32_16x16x32_f16 v[12:15], v[116:119], v[144:147], v[12:15]
    v_mfma_f32_16x16x32_f16 v[16:19], v[116:119], v[148:151], v[16:19]
    v_mfma_f32_16x16x32_f16 v[20:23], v[116:119], v[152:155], v[20:23]
    v_mfma_f32_16x16x32_f16 v[24:27], v[116:119], v[156:159], v[24:27]
    v_mfma_f32_16x16x32_f16 v[28:31], v[116:119], v[160:163], v[28:31]
    v_mfma_f32_16x16x32_f16 v[32:35], v[116:119], v[164:167], v[32:35]
    v_mfma_f32_16x16x32_f16 v[36:39], v[116:119], v[168:171], v[36:39]
    v_mfma_f32_16x16x32_f16 v[16:19], v[120:123], v[144:147], v[16:19]
    v_mfma_f32_16x16x32_f16 v[20:23], v[120:123], v[148:151], v[20:23]
    v_mfma_f32_16x16x32_f16 v[24:27], v[120:123], v[152:155], v[24:27]
    v_mfma_f32_16x16x32_f16 v[28:31], v[120:123], v[156:159], v[28:31]
    v_mfma_f32_16x16x32_f16 v[32:35], v[120:123], v[160:163], v[32:35]
    v_mfma_f32_16x16x32_f16 v[36:39], v[120:123], v[164:167], v[36:39]
    v_mfma_f32_16x16x32_f16 v[20:23], v[124:127], v[144:147], v[20:23]
    v_mfma_f32_16x16x32_f16 v[24:27], v[124:127], v[148:151], v[24:27]
    v_mfma_f32_16x16x32_f16 v[28:31], v[124:127], v[152:155], v[28:31]
    v_mfma_f32_16x16x32_f16 v[32:35], v[124:127], v[156:159], v[32:35]
    v_mfma_f32_16x16x32_f16 v[36:39], v[124:127], v[160:163], v[36:39]
    v_mfma_f32_16x16x32_f16 v[24:27], v[128:131], v[144:147], v[24:27]
    v_mfma_f32_16x16x32_f16 v[28:31], v[128:131], v[148:151], v[28:31]
    v_mfma_f32_16x16x32_f16 v[32:35], v[128:131], v[152:155], v[32:35]
    v_mfma_f32_16x16x32_f16 v[36:39], v[128:131], v[156:159], v[36:39]
    v_mfma_f32_16x16x32_f16 v[28:31], v[132:135], v[144:147], v[28:31]
    v_mfma_f32_16x16x32_f16 v[32:35], v[132:135], v[148:151], v[32:35]
    v_mfma_f32_16x16x32_f16 v[36:39], v[132:135], v[152:155], v[36:39]
    v_mfma_f32_16x16x32_f16 v[32:35], v[136:139], v[144:147], v[32:35]
    v_mfma_f32_16x16x32_f16 v[36:39], v[136:139], v[148:151], v[36:39]
    v_mfma_f32_16x16x32_f16 v[36:39], v[140:143], v[144:147], v[36:39]
    s_barrier
    ds_write_b128 v178, v[8:11] offset:0
    ds_write_b128 v178, v[12:15] offset:1024
    ds_write_b128 v178, v[16:19] offset:2048
    ds_write_b128 v178, v[20:23] offset:3072
    ds_write_b128 v178, v[24:27] offset:4096
    ds_write_b128 v178, v[28:31] offset:5120
    ds_write_b128 v178, v[32:35] offset:6144
    ds_write_b128 v178, v[36:39] offset:7168
    s_add_u32 s20, s4, 8388608
    s_addc_u32 s21, s5, 0
    s_waitcnt lgkmcnt(0)
    s_barrier
    ds_read_b128 v[112:115], v184 offset:17408
    ds_read_b128 v[116:119], v184 offset:17424
    ds_read_b128 v[120:123], v184 offset:25600
    ds_read_b128 v[124:127], v184 offset:25616
    ds_read_b128 v[128:131], v184 offset:52224
    ds_read_b128 v[132:135], v184 offset:52240
    ds_read_b128 v[136:139], v184 offset:60416
    ds_read_b128 v[140:143], v184 offset:60432
    s_waitcnt lgkmcnt(4)
    v_pk_add_f32 v[112:113], v[112:113], v[120:121]
    v_pk_add_f32 v[114:115], v[114:115], v[122:123]
    v_pk_add_f32 v[116:117], v[116:117], v[124:125]
    v_pk_add_f32 v[118:119], v[118:119], v[126:127]
    v_pk_fma_f32 v[112:113], v[112:113], v[228:229], v[240:241]
    v_pk_fma_f32 v[114:115], v[114:115], v[228:229], v[242:243]
    v_pk_fma_f32 v[116:117], v[116:117], v[228:229], v[244:245]
    v_pk_fma_f32 v[118:119], v[118:119], v[228:229], v[246:247]
    v_cvt_pk_bf16_f32 v40, v112, v113
    v_cvt_pk_bf16_f32 v41, v114, v115
    v_cvt_pk_bf16_f32 v42, v116, v117
    v_cvt_pk_bf16_f32 v43, v118, v119
    global_store_dwordx4 v186, v[40:43], s[20:21]
    s_waitcnt lgkmcnt(0)
    v_pk_add_f32 v[128:129], v[128:129], v[136:137]
    v_pk_add_f32 v[130:131], v[130:131], v[138:139]
    v_pk_add_f32 v[132:133], v[132:133], v[140:141]
    v_pk_add_f32 v[134:135], v[134:135], v[142:143]
    v_pk_fma_f32 v[128:129], v[128:129], v[236:237], v[248:249]
    v_pk_fma_f32 v[130:131], v[130:131], v[236:237], v[250:251]
    v_pk_fma_f32 v[132:133], v[132:133], v[236:237], v[252:253]
    v_pk_fma_f32 v[134:135], v[134:135], v[236:237], v[254:255]
    v_cvt_pk_bf16_f32 v44, v128, v129
    v_cvt_pk_bf16_f32 v45, v130, v131
    v_cvt_pk_bf16_f32 v46, v132, v133
    v_cvt_pk_bf16_f32 v47, v134, v135
    global_store_dwordx4 v187, v[44:47], s[20:21]
    s_endpgm
K2_PACK:
    s_load_dwordx8 s[12:19], s[0:1], 80
    s_load_dwordx2 s[20:21], s[0:1], 144
    s_sub_u32 s3, s2, 224
    s_waitcnt lgkmcnt(0)
    s_mov_b32 s6, 896
    s_mov_b32 s10, 14336
    s_mov_b32 s11, -1
    s_cmp_lt_u32 s3, 14
    s_cbranch_scc0 K2_P34
    s_cmp_lt_u32 s3, 7
    s_cselect_b32 s4, s12, s14
    s_cselect_b32 s5, s13, s15
    s_mov_b32 s22, 42991616
    s_cselect_b32 s22, 41943040, s22
    s_cselect_b32 s11, 20480, -1
    s_cselect_b32 s23, 0, 7
    s_sub_u32 s23, s3, s23
    s_mov_b32 s24, 0
    s_branch K2_PGO
K2_P34:
    s_cmp_lt_u32 s3, 42
    s_cbranch_scc0 K2_P4
    s_mov_b32 s4, s16
    s_mov_b32 s5, s17
    s_mov_b32 s6, 3584
    s_mov_b32 s22, 44040192
    s_mov_b32 s11, 24576
    s_sub_u32 s23, s3, 14
    s_mov_b32 s24, 0
    s_branch K2_PGO
K2_P4:
    s_mov_b32 s4, s18
    s_mov_b32 s5, s19
    s_mov_b32 s22, 46137344
    s_mov_b32 s10, 57344
    s_sub_u32 s23, s3, 42
    s_mul_i32 s24, s23, 37
    s_lshr_b32 s24, s24, 8
    s_mul_i32 s25, s24, 7
    s_sub_u32 s23, s23, s25
K2_PGO:
    s_mul_i32 s25, s24, 401408
    s_lshl_b32 s26, s23, 7
    s_add_u32 s25, s25, s26
    s_add_u32 s4, s4, s25
    s_addc_u32 s5, s5, 0
    s_lshl_b32 s25, s23, 2
    s_mul_i32 s25, s25, s10
    s_mul_i32 s26, s24, 14336
    s_add_u32 s25, s25, s26
    s_add_u32 s25, s25, s22
    s_add_u32 s8, s20, s25
    s_addc_u32 s9, s21, 0
    v_lshrrev_b32 v1, 3, v0
    v_and_b32 v2, 7, v0
    v_mul_lo_u32 v3, v1, s6
    v_lshl_add_u32 v3, v2, 4, v3
    s_lshl_b32 s25, s6, 5
    global_load_dwordx4 v[16:19], v3, s[4:5]
    v_add_u32 v3, s25, v3
    global_load_dwordx4 v[20:23], v3, s[4:5]
    v_add_u32 v3, s25, v3
    global_load_dwordx4 v[24:27], v3, s[4:5]
    v_add_u32 v3, s25, v3
    global_load_dwordx4 v[28:31], v3, s[4:5]
    v_add_u32 v3, s25, v3
    global_load_dwordx4 v[32:35], v3, s[4:5]
    v_add_u32 v3, s25, v3
    global_load_dwordx4 v[36:39], v3, s[4:5]
    v_add_u32 v3, s25, v3
    global_load_dwordx4 v[40:43], v3, s[4:5]
    v_add_u32 v3, s25, v3
    global_load_dwordx4 v[44:47], v3, s[4:5]
    v_add_u32 v3, s25, v3
    global_load_dwordx4 v[48:51], v3, s[4:5]
    v_add_u32 v3, s25, v3
    global_load_dwordx4 v[52:55], v3, s[4:5]
    v_add_u32 v3, s25, v3
    global_load_dwordx4 v[56:59], v3, s[4:5]
    v_add_u32 v3, s25, v3
    global_load_dwordx4 v[60:63], v3, s[4:5]
    v_add_u32 v3, s25, v3
    global_load_dwordx4 v[64:67], v3, s[4:5]
    v_add_u32 v3, s25, v3
    global_load_dwordx4 v[68:71], v3, s[4:5]
    v_bfe_u32 v4, v1, 1, 1
    v_bfe_u32 v5, v1, 3, 1
    v_lshlrev_b32 v4, 2, v4
    v_lshl_or_b32 v4, v5, 1, v4
    v_xor_b32 v4, v4, v2
    v_lshlrev_b32 v4, 4, v4
    v_lshl_add_u32 v4, v1, 7, v4
    v_mov_b32 v76, 0x05040100
    v_mov_b32 v77, 0x07060302
    v_cmp_eq_u32 vcc, 1, v5
    s_nop 1
    v_cndmask_b32 v78, v76, v77, vcc
    v_cndmask_b32 v79, v77, v76, vcc
    v_and_b32 v5, 15, v0
    v_bfe_u32 v6, v0, 4, 2
    v_lshrrev_b32 v7, 6, v0
    v_lshrrev_b32 v8, 2, v5
    v_lshl_add_u32 v8, v6, 3, v8
    v_and_b32 v9, 3, v5
    v_lshrrev_b32 v10, 1, v7
    v_lshl_add_u32 v10, v10, 2, v9
    v_and_b32 v11, 1, v7
    v_and_b32 v12, 1, v9
    v_lshl_add_u32 v12, v7, 1, v12
    v_lshrrev_b32 v13, 1, v9
    s_cmp_eq_u32 s11, -1
    s_cselect_b64 s[26:27], -1, 0
    v_cndmask_b32 v10, v10, v12, s[26:27]
    v_cndmask_b32 v11, v11, v13, s[26:27]
    v_bfe_u32 v12, v8, 1, 1
    v_bfe_u32 v13, v8, 3, 1
    v_lshlrev_b32 v12, 2, v12
    v_lshl_or_b32 v12, v13, 1, v12
    v_xor_b32 v10, v10, v12
    v_xor_b32 v11, v11, v13
    v_lshlrev_b32 v9, 7, v8
    v_lshl_add_u32 v9, v10, 4, v9
    v_lshl_add_u32 v9, v11, 3, v9
    v_mul_lo_u32 v10, v7, s10
    v_and_b32 v11, 63, v0
    v_lshl_add_u32 v10, v11, 4, v10
    v_mov_b32 v12, 0x3f803f80
    v_mov_b32 v13, 0x3f803f80
    v_mov_b32 v14, 0x3f803f80
    v_mov_b32 v15, 0x3f803f80
    v_mov_b32 v72, 0
    v_mov_b32 v73, 0
    v_mov_b32 v74, 0
    v_mov_b32 v75, 0
    s_waitcnt vmcnt(13)
    v_perm_b32 v80, v17, v16, v78
    v_perm_b32 v81, v19, v18, v78
    v_perm_b32 v82, v17, v16, v79
    v_perm_b32 v83, v19, v18, v79
    ds_write_b128 v4, v[80:83] offset:0
    s_waitcnt vmcnt(12)
    v_perm_b32 v84, v21, v20, v78
    v_perm_b32 v85, v23, v22, v78
    v_perm_b32 v86, v21, v20, v79
    v_perm_b32 v87, v23, v22, v79
    ds_write_b128 v4, v[84:87] offset:4096
    s_waitcnt vmcnt(11)
    v_perm_b32 v80, v25, v24, v78
    v_perm_b32 v81, v27, v26, v78
    v_perm_b32 v82, v25, v24, v79
    v_perm_b32 v83, v27, v26, v79
    ds_write_b128 v4, v[80:83] offset:8192
    s_waitcnt vmcnt(10)
    v_perm_b32 v84, v29, v28, v78
    v_perm_b32 v85, v31, v30, v78
    v_perm_b32 v86, v29, v28, v79
    v_perm_b32 v87, v31, v30, v79
    ds_write_b128 v4, v[84:87] offset:12288
    s_waitcnt vmcnt(9)
    v_perm_b32 v80, v33, v32, v78
    v_perm_b32 v81, v35, v34, v78
    v_perm_b32 v82, v33, v32, v79
    v_perm_b32 v83, v35, v34, v79
    ds_write_b128 v4, v[80:83] offset:16384
    s_waitcnt vmcnt(8)
    v_perm_b32 v84, v37, v36, v78
    v_perm_b32 v85, v39, v38, v78
    v_perm_b32 v86, v37, v36, v79
    v_perm_b32 v87, v39, v38, v79
    ds_write_b128 v4, v[84:87] offset:20480
    s_waitcnt vmcnt(7)
    v_perm_b32 v80, v41, v40, v78
    v_perm_b32 v81, v43, v42, v78
    v_perm_b32 v82, v41, v40, v79
    v_perm_b32 v83, v43, v42, v79
    ds_write_b128 v4, v[80:83] offset:24576
    s_waitcnt vmcnt(6)
    v_perm_b32 v84, v45, v44, v78
    v_perm_b32 v85, v47, v46, v78
    v_perm_b32 v86, v45, v44, v79
    v_perm_b32 v87, v47, v46, v79
    ds_write_b128 v4, v[84:87] offset:28672
    s_waitcnt vmcnt(5)
    v_perm_b32 v80, v49, v48, v78
    v_perm_b32 v81, v51, v50, v78
    v_perm_b32 v82, v49, v48, v79
    v_perm_b32 v83, v51, v50, v79
    ds_write_b128 v4, v[80:83] offset:32768
    s_waitcnt vmcnt(4)
    v_perm_b32 v84, v53, v52, v78
    v_perm_b32 v85, v55, v54, v78
    v_perm_b32 v86, v53, v52, v79
    v_perm_b32 v87, v55, v54, v79
    ds_write_b128 v4, v[84:87] offset:36864
    s_waitcnt vmcnt(3)
    v_perm_b32 v80, v57, v56, v78
    v_perm_b32 v81, v59, v58, v78
    v_perm_b32 v82, v57, v56, v79
    v_perm_b32 v83, v59, v58, v79
    ds_write_b128 v4, v[80:83] offset:40960
    s_waitcnt vmcnt(2)
    v_perm_b32 v84, v61, v60, v78
    v_perm_b32 v85, v63, v62, v78
    v_perm_b32 v86, v61, v60, v79
    v_perm_b32 v87, v63, v62, v79
    ds_write_b128 v4, v[84:87] offset:45056
    s_waitcnt vmcnt(1)
    v_perm_b32 v80, v65, v64, v78
    v_perm_b32 v81, v67, v66, v78
    v_perm_b32 v82, v65, v64, v79
    v_perm_b32 v83, v67, v66, v79
    ds_write_b128 v4, v[80:83] offset:49152
    s_waitcnt vmcnt(0)
    v_perm_b32 v84, v69, v68, v78
    v_perm_b32 v85, v71, v70, v78
    v_perm_b32 v86, v69, v68, v79
    v_perm_b32 v87, v71, v70, v79
    ds_write_b128 v4, v[84:87] offset:53248
    s_waitcnt lgkmcnt(0)
    s_barrier
    ds_read_b64_tr_b16 v[16:17], v9 offset:0
    ds_read_b64_tr_b16 v[18:19], v9 offset:512
    ds_read_b64_tr_b16 v[20:21], v9 offset:4096
    ds_read_b64_tr_b16 v[22:23], v9 offset:4608
    ds_read_b64_tr_b16 v[24:25], v9 offset:8192
    ds_read_b64_tr_b16 v[26:27], v9 offset:8704
    ds_read_b64_tr_b16 v[28:29], v9 offset:12288
    ds_read_b64_tr_b16 v[30:31], v9 offset:12800
    ds_read_b64_tr_b16 v[32:33], v9 offset:16384
    ds_read_b64_tr_b16 v[34:35], v9 offset:16896
    ds_read_b64_tr_b16 v[36:37], v9 offset:20480
    ds_read_b64_tr_b16 v[38:39], v9 offset:20992
    ds_read_b64_tr_b16 v[40:41], v9 offset:24576
    ds_read_b64_tr_b16 v[42:43], v9 offset:25088
    s_waitcnt lgkmcnt(12)
    global_store_dwordx4 v10, v[16:19], s[8:9] offset:0
    v_mfma_f32_16x16x32_bf16 v[72:75], v[12:15], v[16:19], v[72:75]
    ds_read_b64_tr_b16 v[44:45], v9 offset:28672
    ds_read_b64_tr_b16 v[46:47], v9 offset:29184
    s_waitcnt lgkmcnt(12)
    global_store_dwordx4 v10, v[20:23], s[8:9] offset:1024
    v_mfma_f32_16x16x32_bf16 v[72:75], v[12:15], v[20:23], v[72:75]
    ds_read_b64_tr_b16 v[48:49], v9 offset:32768
    ds_read_b64_tr_b16 v[50:51], v9 offset:33280
    s_waitcnt lgkmcnt(12)
    global_store_dwordx4 v10, v[24:27], s[8:9] offset:2048
    v_mfma_f32_16x16x32_bf16 v[72:75], v[12:15], v[24:27], v[72:75]
    ds_read_b64_tr_b16 v[52:53], v9 offset:36864
    ds_read_b64_tr_b16 v[54:55], v9 offset:37376
    s_waitcnt lgkmcnt(12)
    global_store_dwordx4 v10, v[28:31], s[8:9] offset:3072
    v_mfma_f32_16x16x32_bf16 v[72:75], v[12:15], v[28:31], v[72:75]
    v_add_u32 v10, 4096, v10
    ds_read_b64_tr_b16 v[56:57], v9 offset:40960
    ds_read_b64_tr_b16 v[58:59], v9 offset:41472
    s_waitcnt lgkmcnt(12)
    global_store_dwordx4 v10, v[32:35], s[8:9] offset:0
    v_mfma_f32_16x16x32_bf16 v[72:75], v[12:15], v[32:35], v[72:75]
    ds_read_b64_tr_b16 v[60:61], v9 offset:45056
    ds_read_b64_tr_b16 v[62:63], v9 offset:45568
    s_waitcnt lgkmcnt(12)
    global_store_dwordx4 v10, v[36:39], s[8:9] offset:1024
    v_mfma_f32_16x16x32_bf16 v[72:75], v[12:15], v[36:39], v[72:75]
    ds_read_b64_tr_b16 v[64:65], v9 offset:49152
    ds_read_b64_tr_b16 v[66:67], v9 offset:49664
    s_waitcnt lgkmcnt(12)
    global_store_dwordx4 v10, v[40:43], s[8:9] offset:2048
    v_mfma_f32_16x16x32_bf16 v[72:75], v[12:15], v[40:43], v[72:75]
    ds_read_b64_tr_b16 v[68:69], v9 offset:53248
    ds_read_b64_tr_b16 v[70:71], v9 offset:53760
    s_waitcnt lgkmcnt(12)
    global_store_dwordx4 v10, v[44:47], s[8:9] offset:3072
    v_mfma_f32_16x16x32_bf16 v[72:75], v[12:15], v[44:47], v[72:75]
    v_add_u32 v10, 4096, v10
    s_waitcnt lgkmcnt(10)
    global_store_dwordx4 v10, v[48:51], s[8:9] offset:0
    v_mfma_f32_16x16x32_bf16 v[72:75], v[12:15], v[48:51], v[72:75]
    s_waitcnt lgkmcnt(8)
    global_store_dwordx4 v10, v[52:55], s[8:9] offset:1024
    v_mfma_f32_16x16x32_bf16 v[72:75], v[12:15], v[52:55], v[72:75]
    s_waitcnt lgkmcnt(6)
    global_store_dwordx4 v10, v[56:59], s[8:9] offset:2048
    v_mfma_f32_16x16x32_bf16 v[72:75], v[12:15], v[56:59], v[72:75]
    s_waitcnt lgkmcnt(4)
    global_store_dwordx4 v10, v[60:63], s[8:9] offset:3072
    v_mfma_f32_16x16x32_bf16 v[72:75], v[12:15], v[60:63], v[72:75]
    v_add_u32 v10, 4096, v10
    s_waitcnt lgkmcnt(2)
    global_store_dwordx4 v10, v[64:67], s[8:9] offset:0
    v_mfma_f32_16x16x32_bf16 v[72:75], v[12:15], v[64:67], v[72:75]
    s_waitcnt lgkmcnt(0)
    global_store_dwordx4 v10, v[68:71], s[8:9] offset:1024
    v_mfma_f32_16x16x32_bf16 v[72:75], v[12:15], v[68:71], v[72:75]
    s_cmp_eq_u32 s11, -1
    s_cbranch_scc1 K2_END
    v_cmp_gt_u32 vcc, 16, v11
    s_and_saveexec_b64 s[26:27], vcc
    s_lshl_b32 s25, s23, 8
    s_add_u32 s25, s25, s11
    v_lshrrev_b32 v6, 1, v7
    v_lshl_add_u32 v5, v6, 4, v5
    v_and_b32 v6, 1, v7
    v_lshl_add_u32 v5, v5, 1, v6
    v_lshl_add_u32 v5, v5, 2, s25
    global_store_dword v5, v72, s[20:21]
K2_END:
    s_endpgm
.globl ln_gemm1_kernel
.p2align 8
.type ln_gemm1_kernel,@function
ln_gemm1_kernel:
    s_cmp_ge_u32 s2, 256
    s_cbranch_scc1 K3_END
    s_load_dwordx2 s[4:5], s[0:1], 144
    s_load_dwordx2 s[6:7], s[0:1], 0
    s_and_b32 s3, s2, 7
    s_lshl_b32 s3, s3, 4
    s_lshr_b32 s8, s2, 4
    s_add_u32 s3, s3, s8
    s_bfe_u32 s8, s2, 0x10003
    v_lshrrev_b32 v1, 6, v0
    s_nop 0
    v_readfirstlane_b32 s9, v1
    v_bfe_u32 v4, v0, 4, 2
    v_and_b32 v5, 15, v0
    s_cmp_lt_u32 s9, 4
    s_cbranch_scc1 K3_LN
    s_sub_u32 s9, s9, 4
    v_subrev_u32 v1, 256, v0
    v_lshrrev_b32 v6, 1, v1
    v_and_b32 v7, 1, v1
    v_lshlrev_b32 v8, 12, v6
    v_lshl_add_u32 v8, v7, 4, v8
    s_lshl_b32 s12, s3, 5
    v_add_u32 v8, s12, v8
    v_add_u32 v9, 917504, v8
    v_mul_u32_u24 v10, 40, v6
    v_lshl_add_u32 v10, v7, 4, v10
    s_mul_i32 s13, s3, 14336
    v_lshl_add_u32 v12, v1, 4, s13
    v_mul_u32_u24 v15, 1171, v1
    v_lshrrev_b32 v15, 16, v15
    v_mul_u32_u24 v15, 192, v15
    v_lshl_add_u32 v11, v1, 4, v15
    s_mul_i32 s12, s8, 14
    s_lshl_b32 s13, s9, 1
    s_add_u32 s12, s12, s13
    s_lshl_b32 s13, s12, 6
    v_lshl_add_u32 v14, v5, 3, s13
    s_mul_i32 s13, s12, 14336
    v_and_b32 v15, 63, v0
    v_lshl_add_u32 v15, v15, 4, s13
    v_add_u32 v13, 7168, v12
    s_waitcnt lgkmcnt(0)
    s_add_u32 s16, s4, 8388608
    s_addc_u32 s17, s5, 0
    s_add_u32 s20, s4, 20480
    s_addc_u32 s21, s5, 0
    s_add_u32 s22, s4, 41943040
    s_addc_u32 s23, s5, 0
    global_load_dwordx4 v[140:143], v8, s[16:17]
    global_load_dwordx4 v[144:147], v9, s[16:17]
    global_load_dwordx4 v[148:151], v12, s[6:7]
    global_load_dwordx4 v[152:155], v13, s[6:7]
    s_add_u32 s28, s4, 5376
    s_addc_u32 s29, s5, 0
    s_mov_b32 s30, 7168
    s_mov_b32 s31, 0x00020000
    v_lshlrev_b32 v16, 4, v1
    v_add_u32 v17, 2*1792, v16
    v_cmp_gt_u32 vcc, 112, v1
    s_nop 1
    v_cndmask_b32 v17, v17, v16, vcc
    buffer_load_dwordx4 v[20:23], v17, s[28:31], 0 offen
    s_add_u32 s24, s4, 41943040
    s_addc_u32 s25, s5, 0
    s_mov_b32 s26, 401408
    s_mov_b32 s27, 0x00020000
    s_mov_b32 s32, 0
    s_mov_b32 s33, 4096
    s_mov_b32 s34, 8192
    s_mov_b32 s35, 12288
    s_mov_b32 s36, 16384
    s_mov_b32 s37, 20480
    s_mov_b32 s38, 24576
    global_load_dwordx2 v[2:3], v14, s[20:21]
    s_barrier
    buffer_load_dwordx4 v[24:27], v15, s[24:27], s32 offen offset:0
    buffer_load_dwordx4 v[80:83], v15, s[24:27], s35 offen offset:2048
    buffer_load_dwordx4 v[28:31], v15, s[24:27], s32 offen offset:1024
    buffer_load_dwordx4 v[84:87], v15, s[24:27], s35 offen offset:3072
    s_waitcnt vmcnt(5)
    ds_write_b64 v10, v[140:141]
    ds_write_b64 v10, v[142:143] offset:8
    ds_write_b64 v10, v[144:145] offset:8960
    ds_write_b64 v10, v[146:147] offset:8968
    ds_write_b128 v11, v[148:151] offset:17920
    ds_write_b128 v11, v[152:155] offset:26624
    v_cmp_gt_u32 vcc, 224, v1
    s_and_saveexec_b64 s[40:41], vcc
    ds_write_b128 v16, v[20:23] offset:52480
    s_mov_b64 exec, s[40:41]
    s_waitcnt lgkmcnt(0)
    s_barrier
    buffer_load_dwordx4 v[32:35], v15, s[24:27], s32 offen offset:2048
    buffer_load_dwordx4 v[88:91], v15, s[24:27], s36 offen offset:0
    buffer_load_dwordx4 v[36:39], v15, s[24:27], s32 offen offset:3072
    buffer_load_dwordx4 v[92:95], v15, s[24:27], s36 offen offset:1024
    buffer_load_dwordx4 v[40:43], v15, s[24:27], s33 offen offset:0
    buffer_load_dwordx4 v[96:99], v15, s[24:27], s36 offen offset:2048
    buffer_load_dwordx4 v[44:47], v15, s[24:27], s33 offen offset:1024
    buffer_load_dwordx4 v[100:103], v15, s[24:27], s36 offen offset:3072
    buffer_load_dwordx4 v[48:51], v15, s[24:27], s33 offen offset:2048
    buffer_load_dwordx4 v[104:107], v15, s[24:27], s37 offen offset:0
    buffer_load_dwordx4 v[52:55], v15, s[24:27], s33 offen offset:3072
    buffer_load_dwordx4 v[108:111], v15, s[24:27], s37 offen offset:1024
    buffer_load_dwordx4 v[56:59], v15, s[24:27], s34 offen offset:0
    buffer_load_dwordx4 v[112:115], v15, s[24:27], s37 offen offset:2048
    buffer_load_dwordx4 v[60:63], v15, s[24:27], s34 offen offset:1024
    buffer_load_dwordx4 v[116:119], v15, s[24:27], s37 offen offset:3072
    buffer_load_dwordx4 v[64:67], v15, s[24:27], s34 offen offset:2048
    buffer_load_dwordx4 v[120:123], v15, s[24:27], s38 offen offset:0
    buffer_load_dwordx4 v[68:71], v15, s[24:27], s34 offen offset:3072
    buffer_load_dwordx4 v[124:127], v15, s[24:27], s38 offen offset:1024
    buffer_load_dwordx4 v[72:75], v15, s[24:27], s35 offen offset:0
    buffer_load_dwordx4 v[128:131], v15, s[24:27], s38 offen offset:2048
    buffer_load_dwordx4 v[76:79], v15, s[24:27], s35 offen offset:1024
    buffer_load_dwordx4 v[132:135], v15, s[24:27], s38 offen offset:3072
    v_xor_b32 v6, v4, v5
    v_lshlrev_b32 v7, 10, v5
    v_add_u32 v7, 35840, v7
    v_xor_b32 v8, 0, v6
    v_lshl_add_u32 v8, v8, 4, v7
    v_xor_b32 v9, 4, v6
    v_lshl_add_u32 v9, v9, 4, v7
    v_xor_b32 v10, 8, v6
    v_lshl_add_u32 v10, v10, 4, v7
    v_xor_b32 v11, 12, v6
    v_lshl_add_u32 v11, v11, 4, v7
    v_lshlrev_b32 v12, 4, v4
    s_lshl_b32 s13, s3, 4
    v_lshl_add_u32 v6, v4, 2, s13
    v_mul_u32_u24 v6, 896, v6
    v_lshl_add_u32 v6, v5, 2, v6
    s_lshl_b32 s12, s12, 5
    v_add_u32 v6, s12, v6
    s_add_u32 s20, s4, 20971520
    s_addc_u32 s21, s5, 0
    s_barrier
    ds_read_b128 v[160:163], v12 offset:52224
    ds_read_b128 v[164:167], v12 offset:52288
    ds_read_b128 v[136:139], v8 offset:0
    ds_read_b128 v[140:143], v9 offset:0
    ds_read_b128 v[144:147], v10 offset:0
    ds_read_b128 v[148:151], v11 offset:0
    ds_read_b128 v[152:155], v8 offset:256
    s_waitcnt vmcnt(28) lgkmcnt(5)
    v_mul_f32 v16, v160, v2
    v_mul_f32 v17, v161, v2
    v_mul_f32 v18, v162, v2
    v_mul_f32 v19, v163, v2
    v_mul_f32 v20, v160, v3
    v_mul_f32 v21, v161, v3
    v_mul_f32 v22, v162, v3
    v_mul_f32 v23, v163, v3
    s_waitcnt vmcnt(26) lgkmcnt(4)
    v_mfma_f32_16x16x32_bf16 v[16:19], v[136:139], v[24:27], v[16:19]
    v_mfma_f32_16x16x32_bf16 v[20:23], v[136:139], v[80:83], v[20:23]
    ds_read_b128 v[136:139], v9 offset:256
    s_waitcnt vmcnt(24) lgkmcnt(4)
    v_mfma_f32_16x16x32_bf16 v[16:19], v[140:143], v[28:31], v[16:19]
    v_mfma_f32_16x16x32_bf16 v[20:23], v[140:143], v[84:87], v[20:23]
    ds_read_b128 v[140:143], v10 offset:256
    s_waitcnt vmcnt(22) lgkmcnt(4)
    v_mfma_f32_16x16x32_bf16 v[16:19], v[144:147], v[32:35], v[16:19]
    v_mfma_f32_16x16x32_bf16 v[20:23], v[144:147], v[88:91], v[20:23]
    ds_read_b128 v[144:147], v11 offset:256
    s_waitcnt vmcnt(20) lgkmcnt(4)
    v_mfma_f32_16x16x32_bf16 v[16:19], v[148:151], v[36:39], v[16:19]
    v_mfma_f32_16x16x32_bf16 v[20:23], v[148:151], v[92:95], v[20:23]
    ds_read_b128 v[148:151], v8 offset:512
    s_waitcnt vmcnt(18) lgkmcnt(4)
    v_mfma_f32_16x16x32_bf16 v[16:19], v[152:155], v[40:43], v[16:19]
    v_mfma_f32_16x16x32_bf16 v[20:23], v[152:155], v[96:99], v[20:23]
    ds_read_b128 v[152:155], v9 offset:512
    s_waitcnt vmcnt(16) lgkmcnt(4)
    v_mfma_f32_16x16x32_bf16 v[16:19], v[136:139], v[44:47], v[16:19]
    v_mfma_f32_16x16x32_bf16 v[20:23], v[136:139], v[100:103], v[20:23]
    ds_read_b128 v[136:139], v10 offset:512
    s_waitcnt vmcnt(14) lgkmcnt(4)
    v_mfma_f32_16x16x32_bf16 v[16:19], v[140:143], v[48:51], v[16:19]
    v_mfma_f32_16x16x32_bf16 v[20:23], v[140:143], v[104:107], v[20:23]
    ds_read_b128 v[140:143], v11 offset:512
    s_waitcnt vmcnt(12) lgkmcnt(4)
    v_mfma_f32_16x16x32_bf16 v[16:19], v[144:147], v[52:55], v[16:19]
    v_mfma_f32_16x16x32_bf16 v[20:23], v[144:147], v[108:111], v[20:23]
    ds_read_b128 v[144:147], v8 offset:768
    s_waitcnt vmcnt(10) lgkmcnt(4)
    v_mfma_f32_16x16x32_bf16 v[16:19], v[148:151], v[56:59], v[16:19]
    v_mfma_f32_16x16x32_bf16 v[20:23], v[148:151], v[112:115], v[20:23]
    ds_read_b128 v[148:151], v9 offset:768
    s_waitcnt vmcnt(8) lgkmcnt(4)
    v_mfma_f32_16x16x32_bf16 v[16:19], v[152:155], v[60:63], v[16:19]
    v_mfma_f32_16x16x32_bf16 v[20:23], v[152:155], v[116:119], v[20:23]
    s_waitcnt vmcnt(6) lgkmcnt(3)
    v_mfma_f32_16x16x32_bf16 v[16:19], v[136:139], v[64:67], v[16:19]
    v_mfma_f32_16x16x32_bf16 v[20:23], v[136:139], v[120:123], v[20:23]
    s_waitcnt vmcnt(4) lgkmcnt(2)
    v_mfma_f32_16x16x32_bf16 v[16:19], v[140:143], v[68:71], v[16:19]
    v_mfma_f32_16x16x32_bf16 v[20:23], v[140:143], v[124:127], v[20:23]
    s_waitcnt vmcnt(2) lgkmcnt(1)
    v_mfma_f32_16x16x32_bf16 v[16:19], v[144:147], v[72:75], v[16:19]
    v_mfma_f32_16x16x32_bf16 v[20:23], v[144:147], v[128:131], v[20:23]
    s_waitcnt vmcnt(0) lgkmcnt(0)
    v_mfma_f32_16x16x32_bf16 v[16:19], v[148:151], v[76:79], v[16:19]
    v_mfma_f32_16x16x32_bf16 v[20:23], v[148:151], v[132:135], v[20:23]
    v_mov_b32 v24, 0xbdd2d3e8
    v_mov_b32 v25, 0xbdd2d3e8
    v_mov_b32 v26, 0xc0135761
    v_mov_b32 v27, 0xc0135761
    v_mov_b32 v28, 0x3f800000
    v_mov_b32 v29, 0x3f800000
    s_nop 0
    v_pk_mul_f32 v[16:17], v[16:17], v[164:165]
    v_pk_mul_f32 v[18:19], v[18:19], v[166:167]
    v_pk_mul_f32 v[20:21], v[20:21], v[164:165]
    v_pk_mul_f32 v[22:23], v[22:23], v[166:167]
    v_pk_mul_f32 v[32:33], v[16:17], v[16:17]
    v_pk_mul_f32 v[34:35], v[18:19], v[18:19]
    v_pk_mul_f32 v[36:37], v[20:21], v[20:21]
    v_pk_mul_f32 v[38:39], v[22:23], v[22:23]
    v_pk_fma_f32 v[32:33], v[32:33], v[24:25], v[26:27]
    v_pk_fma_f32 v[34:35], v[34:35], v[24:25], v[26:27]
    v_pk_fma_f32 v[36:37], v[36:37], v[24:25], v[26:27]
    v_pk_fma_f32 v[38:39], v[38:39], v[24:25], v[26:27]
    v_pk_mul_f32 v[32:33], v[32:33], v[16:17]
    v_pk_mul_f32 v[34:35], v[34:35], v[18:19]
    v_pk_mul_f32 v[36:37], v[36:37], v[20:21]
    v_pk_mul_f32 v[38:39], v[38:39], v[22:23]
    v_exp_f32 v32, v32
    v_exp_f32 v33, v33
    v_exp_f32 v34, v34
    v_exp_f32 v35, v35
    v_exp_f32 v36, v36
    v_exp_f32 v37, v37
    v_exp_f32 v38, v38
    v_exp_f32 v39, v39
    v_pk_add_f32 v[32:33], v[32:33], v[28:29]
    v_pk_add_f32 v[34:35], v[34:35], v[28:29]
    v_pk_add_f32 v[36:37], v[36:37], v[28:29]
    v_pk_add_f32 v[38:39], v[38:39], v[28:29]
    v_rcp_f32 v32, v32
    v_rcp_f32 v33, v33
    v_rcp_f32 v34, v34
    v_rcp_f32 v35, v35
    v_rcp_f32 v36, v36
    v_rcp_f32 v37, v37
    v_rcp_f32 v38, v38
    v_rcp_f32 v39, v39
    v_pk_mul_f32 v[16:17], v[16:17], v[32:33]
    v_pk_mul_f32 v[18:19], v[18:19], v[34:35]
    v_pk_mul_f32 v[20:21], v[20:21], v[36:37]
    v_pk_mul_f32 v[22:23], v[22:23], v[38:39]
    v_cvt_pk_bf16_f32 v40, v16, v20
    v_cvt_pk_bf16_f32 v41, v17, v21
    v_cvt_pk_bf16_f32 v42, v18, v22
    v_cvt_pk_bf16_f32 v43, v19, v23
    global_store_dword v6, v40, s[20:21] offset:0
    global_store_dword v6, v41, s[20:21] offset:896
    global_store_dword v6, v42, s[20:21] offset:1792
    global_store_dword v6, v43, s[20:21] offset:2688
    s_endpgm
K3_LN:
    v_and_b32 v2, 3, v0
    v_bfe_u32 v3, v0, 2, 2
    v_lshlrev_b32 v11, 6, v4
    v_lshl_add_u32 v11, v3, 4, v11
    s_waitcnt lgkmcnt(0)
    s_barrier
    v_lshlrev_b32 v6, 4, v4
    v_lshl_add_u32 v6, v2, 2, v6
    v_add_u32 v6, v6, v3
    v_mul_u32_u24 v6, 40, v6
    s_lshl_b32 s12, s9, 3
    v_add_u32 v6, s12, v6
    s_lshl_b32 s12, s9, 2
    v_add_u32 v12, s12, v2
    v_mul_u32_u24 v8, 1088, v12
    v_lshrrev_b32 v9, 1, v11
    v_add_u32 v8, v8, v9
    v_mov_b32 v15, 0x3f803f80
    v_lshrrev_b32 v13, 1, v3
    v_lshl_add_u32 v13, v4, 1, v13
    v_xor_b32 v13, v13, v12
    v_lshlrev_b32 v13, 4, v13
    v_lshl_add_u32 v13, v12, 10, v13
    v_and_b32 v14, 1, v3
    v_lshl_add_u32 v13, v14, 3, v13
    v_add_u32 v13, 35840, v13
    v_xor_b32 v14, 128, v13
    v_lshlrev_b32 v10, 2, v12
    v_and_b32 v7, 63, v0
    v_cmp_gt_u32 s[28:29], 4, v7
    s_barrier
    ds_read_b64_tr_b16 v[30:31], v6 offset:0
    ds_read_b64 v[16:17], v8 offset:17920
    ds_read_b64_tr_b16 v[32:33], v6 offset:2560
    ds_read_b64 v[18:19], v8 offset:18048
    ds_read_b64_tr_b16 v[34:35], v6 offset:5120
    ds_read_b64 v[20:21], v8 offset:18176
    ds_read_b64_tr_b16 v[36:37], v6 offset:7680
    ds_read_b64 v[22:23], v8 offset:18304
    ds_read_b64_tr_b16 v[38:39], v6 offset:10240
    ds_read_b64 v[24:25], v8 offset:18432
    ds_read_b64_tr_b16 v[40:41], v6 offset:12800
    ds_read_b64 v[26:27], v8 offset:18560
    ds_read_b64_tr_b16 v[42:43], v6 offset:15360
    ds_read_b64 v[28:29], v8 offset:18688
    s_waitcnt lgkmcnt(12)
    v_lshlrev_b32 v100, 16, v16
    v_and_b32 v101, 0xffff0000, v16
    v_lshlrev_b32 v128, 16, v30
    v_and_b32 v129, 0xffff0000, v30
    v_pk_add_f32 v[100:101], v[100:101], v[128:129]
    v_lshlrev_b32 v102, 16, v17
    v_and_b32 v103, 0xffff0000, v17
    v_lshlrev_b32 v128, 16, v31
    v_and_b32 v129, 0xffff0000, v31
    v_pk_add_f32 v[102:103], v[102:103], v[128:129]
    s_waitcnt lgkmcnt(10)
    v_lshlrev_b32 v104, 16, v18
    v_and_b32 v105, 0xffff0000, v18
    v_lshlrev_b32 v128, 16, v32
    v_and_b32 v129, 0xffff0000, v32
    v_pk_add_f32 v[104:105], v[104:105], v[128:129]
    v_lshlrev_b32 v106, 16, v19
    v_and_b32 v107, 0xffff0000, v19
    v_lshlrev_b32 v128, 16, v33
    v_and_b32 v129, 0xffff0000, v33
    v_pk_add_f32 v[106:107], v[106:107], v[128:129]
    s_waitcnt lgkmcnt(8)
    v_lshlrev_b32 v108, 16, v20
    v_and_b32 v109, 0xffff0000, v20
    v_lshlrev_b32 v128, 16, v34
    v_and_b32 v129, 0xffff0000, v34
    v_pk_add_f32 v[108:109], v[108:109], v[128:129]
    v_lshlrev_b32 v110, 16, v21
    v_and_b32 v111, 0xffff0000, v21
    v_lshlrev_b32 v128, 16, v35
    v_and_b32 v129, 0xffff0000, v35
    v_pk_add_f32 v[110:111], v[110:111], v[128:129]
    s_waitcnt lgkmcnt(6)
    v_lshlrev_b32 v112, 16, v22
    v_and_b32 v113, 0xffff0000, v22
    v_lshlrev_b32 v128, 16, v36
    v_and_b32 v129, 0xffff0000, v36
    v_pk_add_f32 v[112:113], v[112:113], v[128:129]
    v_lshlrev_b32 v114, 16, v23
    v_and_b32 v115, 0xffff0000, v23
    v_lshlrev_b32 v128, 16, v37
    v_and_b32 v129, 0xffff0000, v37
    v_pk_add_f32 v[114:115], v[114:115], v[128:129]
    s_waitcnt lgkmcnt(4)
    v_lshlrev_b32 v116, 16, v24
    v_and_b32 v117, 0xffff0000, v24
    v_lshlrev_b32 v128, 16, v38
    v_and_b32 v129, 0xffff0000, v38
    v_pk_add_f32 v[116:117], v[116:117], v[128:129]
    v_lshlrev_b32 v118, 16, v25
    v_and_b32 v119, 0xffff0000, v25
    v_lshlrev_b32 v128, 16, v39
    v_and_b32 v129, 0xffff0000, v39
    v_pk_add_f32 v[118:119], v[118:119], v[128:129]
    s_waitcnt lgkmcnt(2)
    v_lshlrev_b32 v120, 16, v26
    v_and_b32 v121, 0xffff0000, v26
    v_lshlrev_b32 v128, 16, v40
    v_and_b32 v129, 0xffff0000, v40
    v_pk_add_f32 v[120:121], v[120:121], v[128:129]
    v_lshlrev_b32 v122, 16, v27
    v_and_b32 v123, 0xffff0000, v27
    v_lshlrev_b32 v128, 16, v41
    v_and_b32 v129, 0xffff0000, v41
    v_pk_add_f32 v[122:123], v[122:123], v[128:129]
    s_waitcnt lgkmcnt(0)
    v_lshlrev_b32 v124, 16, v28
    v_and_b32 v125, 0xffff0000, v28
    v_lshlrev_b32 v128, 16, v42
    v_and_b32 v129, 0xffff0000, v42
    v_pk_add_f32 v[124:125], v[124:125], v[128:129]
    v_lshlrev_b32 v126, 16, v29
    v_and_b32 v127, 0xffff0000, v29
    v_lshlrev_b32 v128, 16, v43
    v_and_b32 v129, 0xffff0000, v43
    v_pk_add_f32 v[126:127], v[126:127], v[128:129]
    ds_read_b128 v[72:75], v11 offset:52480
    ds_read_b128 v[44:47], v11 offset:54272
    ds_read_b128 v[76:79], v11 offset:52736
    ds_read_b128 v[48:51], v11 offset:54528
    ds_read_b128 v[80:83], v11 offset:52992
    ds_read_b128 v[52:55], v11 offset:54784
    ds_read_b128 v[84:87], v11 offset:53248
    ds_read_b128 v[56:59], v11 offset:55040
    ds_read_b128 v[88:91], v11 offset:53504
    ds_read_b128 v[60:63], v11 offset:55296
    ds_read_b128 v[92:95], v11 offset:53760
    ds_read_b128 v[64:67], v11 offset:55552
    ds_read_b128 v[96:99], v11 offset:54016
    ds_read_b128 v[68:71], v11 offset:55808
    v_cvt_pk_bf16_f32 v16, v100, v101
    v_cvt_pk_bf16_f32 v17, v102, v103
    v_cvt_pk_bf16_f32 v18, v104, v105
    v_cvt_pk_bf16_f32 v19, v106, v107
    v_cvt_pk_bf16_f32 v20, v108, v109
    v_cvt_pk_bf16_f32 v21, v110, v111
    v_cvt_pk_bf16_f32 v22, v112, v113
    v_cvt_pk_bf16_f32 v23, v114, v115
    v_cvt_pk_bf16_f32 v24, v116, v117
    v_cvt_pk_bf16_f32 v25, v118, v119
    v_cvt_pk_bf16_f32 v26, v120, v121
    v_cvt_pk_bf16_f32 v27, v122, v123
    v_cvt_pk_bf16_f32 v28, v124, v125
    v_cvt_pk_bf16_f32 v29, v126, v127
    ds_write_b64 v8, v[16:17] offset:17920
    ds_write_b64 v8, v[18:19] offset:18048
    ds_write_b64 v8, v[20:21] offset:18176
    ds_write_b64 v8, v[22:23] offset:18304
    ds_write_b64 v8, v[24:25] offset:18432
    ds_write_b64 v8, v[26:27] offset:18560
    ds_write_b64 v8, v[28:29] offset:18688
    v_dot2_f32_bf16 v142, v16, v15, 0
    v_dot2_f32_bf16 v143, v16, v16, 0
    v_dot2_f32_bf16 v142, v17, v15, v142
    v_dot2_f32_bf16 v143, v17, v17, v143
    v_dot2_f32_bf16 v142, v18, v15, v142
    v_dot2_f32_bf16 v143, v18, v18, v143
    v_dot2_f32_bf16 v142, v19, v15, v142
    v_dot2_f32_bf16 v143, v19, v19, v143
    v_dot2_f32_bf16 v142, v20, v15, v142
    v_dot2_f32_bf16 v143, v20, v20, v143
    v_dot2_f32_bf16 v142, v21, v15, v142
    v_dot2_f32_bf16 v143, v21, v21, v143
    v_dot2_f32_bf16 v142, v22, v15, v142
    v_dot2_f32_bf16 v143, v22, v22, v143
    v_dot2_f32_bf16 v142, v23, v15, v142
    v_dot2_f32_bf16 v143, v23, v23, v143
    v_dot2_f32_bf16 v142, v24, v15, v142
    v_dot2_f32_bf16 v143, v24, v24, v143
    v_dot2_f32_bf16 v142, v25, v15, v142
    v_dot2_f32_bf16 v143, v25, v25, v143
    v_dot2_f32_bf16 v142, v26, v15, v142
    v_dot2_f32_bf16 v143, v26, v26, v143
    v_dot2_f32_bf16 v142, v27, v15, v142
    v_dot2_f32_bf16 v143, v27, v27, v143
    v_dot2_f32_bf16 v142, v28, v15, v142
    v_dot2_f32_bf16 v143, v28, v28, v143
    v_dot2_f32_bf16 v142, v29, v15, v142
    v_dot2_f32_bf16 v143, v29, v29, v143
    s_nop 1
    v_add_f32_dpp v142, v142, v142 row_ror:4 row_mask:0xf bank_mask:0xf
    v_add_f32_dpp v143, v143, v143 row_ror:4 row_mask:0xf bank_mask:0xf
    s_nop 0
    v_add_f32_dpp v142, v142, v142 row_ror:8 row_mask:0xf bank_mask:0xf
    v_add_f32_dpp v143, v143, v143 row_ror:8 row_mask:0xf bank_mask:0xf
    v_mov_b32 v144, v142
    v_mov_b32 v145, v143
    s_nop 0
    v_permlane32_swap_b32 v142, v144
    v_permlane32_swap_b32 v143, v145
    v_add_f32 v142, v142, v144
    v_add_f32 v143, v143, v145
    v_mov_b32 v144, v142
    v_mov_b32 v145, v143
    s_nop 0
    v_permlane16_swap_b32 v142, v144
    v_permlane16_swap_b32 v143, v145
    v_add_f32 v142, v142, v144
    v_add_f32 v143, v143, v145
    v_mul_f32 v142, 0x3b124925, v142
    v_mul_f32 v143, 0x3b124925, v143
    v_fma_f32 v143, -v142, v142, v143
    v_max_f32 v143, 0, v143
    v_cvt_pk_bf16_f32 v146, v142, v142
    v_lshlrev_b32 v146, 16, v146
    v_cvt_pk_bf16_f32 v148, v143, v143
    v_lshlrev_b32 v148, 16, v148
    v_add_f32 v148, 0x3727c5ac, v148
    v_cvt_pk_bf16_f32 v148, v148, v148
    v_lshlrev_b32 v148, 16, v148
    v_sqrt_f32 v148, v148
    s_nop 0
    v_cvt_pk_bf16_f32 v148, v148, v148
    v_lshlrev_b32 v148, 16, v148
    v_rcp_f32 v150, v148
    v_mov_b32 v147, v146
    v_mov_b32 v151, v150
    v_lshlrev_b32 v100, 16, v16
    v_and_b32 v101, 0xffff0000, v16
    v_lshlrev_b32 v102, 16, v17
    v_and_b32 v103, 0xffff0000, v17
    v_lshlrev_b32 v104, 16, v18
    v_and_b32 v105, 0xffff0000, v18
    v_lshlrev_b32 v106, 16, v19
    v_and_b32 v107, 0xffff0000, v19
    v_lshlrev_b32 v108, 16, v20
    v_and_b32 v109, 0xffff0000, v20
    v_lshlrev_b32 v110, 16, v21
    v_and_b32 v111, 0xffff0000, v21
    v_lshlrev_b32 v112, 16, v22
    v_and_b32 v113, 0xffff0000, v22
    v_lshlrev_b32 v114, 16, v23
    v_and_b32 v115, 0xffff0000, v23
    v_lshlrev_b32 v116, 16, v24
    v_and_b32 v117, 0xffff0000, v24
    v_lshlrev_b32 v118, 16, v25
    v_and_b32 v119, 0xffff0000, v25
    v_lshlrev_b32 v120, 16, v26
    v_and_b32 v121, 0xffff0000, v26
    v_lshlrev_b32 v122, 16, v27
    v_and_b32 v123, 0xffff0000, v27
    v_lshlrev_b32 v124, 16, v28
    v_and_b32 v125, 0xffff0000, v28
    v_lshlrev_b32 v126, 16, v29
    v_and_b32 v127, 0xffff0000, v29
    s_waitcnt lgkmcnt(0)
    v_pk_add_f32 v[100:101], v[100:101], v[146:147] neg_lo:[0,1] neg_hi:[0,1]
    v_pk_add_f32 v[102:103], v[102:103], v[146:147] neg_lo:[0,1] neg_hi:[0,1]
    v_pk_add_f32 v[104:105], v[104:105], v[146:147] neg_lo:[0,1] neg_hi:[0,1]
    v_pk_add_f32 v[106:107], v[106:107], v[146:147] neg_lo:[0,1] neg_hi:[0,1]
    v_pk_add_f32 v[108:109], v[108:109], v[146:147] neg_lo:[0,1] neg_hi:[0,1]
    v_pk_add_f32 v[110:111], v[110:111], v[146:147] neg_lo:[0,1] neg_hi:[0,1]
    v_pk_add_f32 v[112:113], v[112:113], v[146:147] neg_lo:[0,1] neg_hi:[0,1]
    v_pk_add_f32 v[114:115], v[114:115], v[146:147] neg_lo:[0,1] neg_hi:[0,1]
    v_pk_add_f32 v[116:117], v[116:117], v[146:147] neg_lo:[0,1] neg_hi:[0,1]
    v_pk_add_f32 v[118:119], v[118:119], v[146:147] neg_lo:[0,1] neg_hi:[0,1]
    v_pk_add_f32 v[120:121], v[120:121], v[146:147] neg_lo:[0,1] neg_hi:[0,1]
    v_pk_add_f32 v[122:123], v[122:123], v[146:147] neg_lo:[0,1] neg_hi:[0,1]
    v_pk_add_f32 v[124:125], v[124:125], v[146:147] neg_lo:[0,1] neg_hi:[0,1]
    v_pk_add_f32 v[126:127], v[126:127], v[146:147] neg_lo:[0,1] neg_hi:[0,1]
    v_pk_mul_f32 v[44:45], v[44:45], v[150:151]
    v_pk_mul_f32 v[46:47], v[46:47], v[150:151]
    v_pk_mul_f32 v[48:49], v[48:49], v[150:151]
    v_pk_mul_f32 v[50:51], v[50:51], v[150:151]
    v_pk_mul_f32 v[52:53], v[52:53], v[150:151]
    v_pk_mul_f32 v[54:55], v[54:55], v[150:151]
    v_pk_mul_f32 v[56:57], v[56:57], v[150:151]
    v_pk_mul_f32 v[58:59], v[58:59], v[150:151]
    v_pk_mul_f32 v[60:61], v[60:61], v[150:151]
    v_pk_mul_f32 v[62:63], v[62:63], v[150:151]
    v_pk_mul_f32 v[64:65], v[64:65], v[150:151]
    v_pk_mul_f32 v[66:67], v[66:67], v[150:151]
    v_pk_mul_f32 v[68:69], v[68:69], v[150:151]
    v_pk_mul_f32 v[70:71], v[70:71], v[150:151]
    v_pk_fma_f32 v[100:101], v[100:101], v[44:45], v[72:73]
    v_pk_fma_f32 v[102:103], v[102:103], v[46:47], v[74:75]
    v_pk_fma_f32 v[104:105], v[104:105], v[48:49], v[76:77]
    v_pk_fma_f32 v[106:107], v[106:107], v[50:51], v[78:79]
    v_pk_fma_f32 v[108:109], v[108:109], v[52:53], v[80:81]
    v_pk_fma_f32 v[110:111], v[110:111], v[54:55], v[82:83]
    v_pk_fma_f32 v[112:113], v[112:113], v[56:57], v[84:85]
    v_pk_fma_f32 v[114:115], v[114:115], v[58:59], v[86:87]
    v_pk_fma_f32 v[116:117], v[116:117], v[60:61], v[88:89]
    v_pk_fma_f32 v[118:119], v[118:119], v[62:63], v[90:91]
    v_pk_fma_f32 v[120:121], v[120:121], v[64:65], v[92:93]
    v_pk_fma_f32 v[122:123], v[122:123], v[66:67], v[94:95]
    v_pk_fma_f32 v[124:125], v[124:125], v[68:69], v[96:97]
    v_pk_fma_f32 v[126:127], v[126:127], v[70:71], v[98:99]
    v_cvt_pk_bf16_f32 v30, v100, v101
    v_cvt_pk_bf16_f32 v31, v102, v103
    v_cvt_pk_bf16_f32 v32, v104, v105
    v_cvt_pk_bf16_f32 v33, v106, v107
    v_cvt_pk_bf16_f32 v34, v108, v109
    v_cvt_pk_bf16_f32 v35, v110, v111
    v_cvt_pk_bf16_f32 v36, v112, v113
    v_cvt_pk_bf16_f32 v37, v114, v115
    v_cvt_pk_bf16_f32 v38, v116, v117
    v_cvt_pk_bf16_f32 v39, v118, v119
    v_cvt_pk_bf16_f32 v40, v120, v121
    v_cvt_pk_bf16_f32 v41, v122, v123
    v_cvt_pk_bf16_f32 v42, v124, v125
    v_cvt_pk_bf16_f32 v43, v126, v127
    ds_write_b64 v13, v[30:31] offset:0
    ds_write_b64 v14, v[32:33] offset:0
    ds_write_b64 v13, v[34:35] offset:256
    ds_write_b64 v14, v[36:37] offset:256
    ds_write_b64 v13, v[38:39] offset:512
    ds_write_b64 v14, v[40:41] offset:512
    ds_write_b64 v13, v[42:43] offset:768
    v_dot2_f32_bf16 v142, v30, v15, 0
    v_dot2_f32_bf16 v143, v30, v30, 0
    v_dot2_f32_bf16 v142, v31, v15, v142
    v_dot2_f32_bf16 v143, v31, v31, v143
    v_dot2_f32_bf16 v142, v32, v15, v142
    v_dot2_f32_bf16 v143, v32, v32, v143
    v_dot2_f32_bf16 v142, v33, v15, v142
    v_dot2_f32_bf16 v143, v33, v33, v143
    v_dot2_f32_bf16 v142, v34, v15, v142
    v_dot2_f32_bf16 v143, v34, v34, v143
    v_dot2_f32_bf16 v142, v35, v15, v142
    v_dot2_f32_bf16 v143, v35, v35, v143
    v_dot2_f32_bf16 v142, v36, v15, v142
    v_dot2_f32_bf16 v143, v36, v36, v143
    v_dot2_f32_bf16 v142, v37, v15, v142
    v_dot2_f32_bf16 v143, v37, v37, v143
    v_dot2_f32_bf16 v142, v38, v15, v142
    v_dot2_f32_bf16 v143, v38, v38, v143
    v_dot2_f32_bf16 v142, v39, v15, v142
    v_dot2_f32_bf16 v143, v39, v39, v143
    v_dot2_f32_bf16 v142, v40, v15, v142
    v_dot2_f32_bf16 v143, v40, v40, v143
    v_dot2_f32_bf16 v142, v41, v15, v142
    v_dot2_f32_bf16 v143, v41, v41, v143
    v_dot2_f32_bf16 v142, v42, v15, v142
    v_dot2_f32_bf16 v143, v42, v42, v143
    v_dot2_f32_bf16 v142, v43, v15, v142
    v_dot2_f32_bf16 v143, v43, v43, v143
    s_nop 1
    v_add_f32_dpp v142, v142, v142 row_ror:4 row_mask:0xf bank_mask:0xf
    v_add_f32_dpp v143, v143, v143 row_ror:4 row_mask:0xf bank_mask:0xf
    s_nop 0
    v_add_f32_dpp v142, v142, v142 row_ror:8 row_mask:0xf bank_mask:0xf
    v_add_f32_dpp v143, v143, v143 row_ror:8 row_mask:0xf bank_mask:0xf
    v_mov_b32 v144, v142
    v_mov_b32 v145, v143
    s_nop 0
    v_permlane32_swap_b32 v142, v144
    v_permlane32_swap_b32 v143, v145
    v_add_f32 v142, v142, v144
    v_add_f32 v143, v143, v145
    v_mov_b32 v144, v142
    v_mov_b32 v145, v143
    s_nop 0
    v_permlane16_swap_b32 v142, v144
    v_permlane16_swap_b32 v143, v145
    v_add_f32 v142, v142, v144
    v_add_f32 v143, v143, v145
    v_mul_f32 v142, 0x3b124925, v142
    v_mul_f32 v143, 0x3b124925, v143
    v_fma_f32 v143, -v142, v142, v143
    v_max_f32 v143, 0, v143
    v_cvt_pk_bf16_f32 v146, v142, v142
    v_lshlrev_b32 v146, 16, v146
    v_cvt_pk_bf16_f32 v148, v143, v143
    v_lshlrev_b32 v148, 16, v148
    v_add_f32 v148, 0x3727c5ac, v148
    v_cvt_pk_bf16_f32 v148, v148, v148
    v_lshlrev_b32 v148, 16, v148
    v_sqrt_f32 v148, v148
    s_nop 0
    v_cvt_pk_bf16_f32 v148, v148, v148
    v_lshlrev_b32 v148, 16, v148
    v_rcp_f32 v150, v148
    v_sub_f32 v146, 0, v146
    s_and_saveexec_b64 s[22:23], s[28:29]
    ds_write_b32 v10, v146 offset:52224
    ds_write_b32 v10, v150 offset:52288
    s_mov_b64 exec, s[22:23]
    s_waitcnt lgkmcnt(0)
    s_barrier
    s_mul_i32 s12, s8, 28
    s_mul_i32 s13, s3, 14336
    s_add_u32 s16, s4, 12582912
    s_addc_u32 s17, s5, 0
    s_mov_b32 s18, 1835008
    s_mov_b32 s19, 0x00020000
    s_add_u32 s20, s4, 16777216
    s_addc_u32 s21, s5, 0
    s_mov_b32 s22, 1835008
    s_mov_b32 s23, 0x00020000
    v_add_u32 v2, 0, v0
    v_mul_u32_u24 v3, 2341, v2
    v_lshrrev_b32 v3, 16, v3
    v_mul_u32_u24 v4, 28, v3
    v_sub_u32 v4, v2, v4
    v_add_u32 v4, s12, v4
    v_and_b32 v9, 15, v3
    v_mul_u32_u24 v5, 1088, v9
    v_lshl_add_u32 v5, v4, 4, v5
    ds_read_b128 v[16:19], v5 offset:17920
    v_xor_b32 v6, v4, v9
    v_lshlrev_b32 v6, 4, v6
    v_lshl_add_u32 v6, v9, 10, v6
    ds_read_b128 v[20:23], v6 offset:35840
    v_mul_u32_u24 v7, 896, v3
    v_lshl_add_u32 v7, v4, 4, v7
    v_add_u32 v40, s13, v7
    v_add_u32 v2, 256, v0
    v_mul_u32_u24 v3, 2341, v2
    v_lshrrev_b32 v3, 16, v3
    v_mul_u32_u24 v4, 28, v3
    v_sub_u32 v4, v2, v4
    v_add_u32 v4, s12, v4
    v_and_b32 v9, 15, v3
    v_mul_u32_u24 v5, 1088, v9
    v_lshl_add_u32 v5, v4, 4, v5
    ds_read_b128 v[24:27], v5 offset:17920
    v_xor_b32 v6, v4, v9
    v_lshlrev_b32 v6, 4, v6
    v_lshl_add_u32 v6, v9, 10, v6
    ds_read_b128 v[28:31], v6 offset:35840
    v_mul_u32_u24 v7, 896, v3
    v_lshl_add_u32 v7, v4, 4, v7
    v_add_u32 v41, s13, v7
    v_cmp_gt_u32 vcc, 16, v3
    v_mov_b32 v7, 0x80000000
    s_nop 0
    v_cndmask_b32 v41, v7, v41, vcc
    s_waitcnt lgkmcnt(2)
    buffer_store_dwordx4 v[16:19], v40, s[16:19], 0 offen
    buffer_store_dwordx4 v[20:23], v40, s[20:23], 0 offen
    s_waitcnt lgkmcnt(0)
    buffer_store_dwordx4 v[24:27], v41, s[16:19], 0 offen
    buffer_store_dwordx4 v[28:31], v41, s[20:23], 0 offen
K3_END:
    s_endpgm
.globl gemm2_kernel
.p2align 8
.type gemm2_kernel,@function
gemm2_kernel:
    s_cmp_ge_u32 s2, 256
    s_cbranch_scc1 K4_END
    s_load_dwordx2 s[4:5], s[0:1], 144
    s_and_b32 s3, s2, 7
    s_lshl_b32 s3, s3, 3
    s_lshr_b32 s8, s2, 5
    s_add_u32 s3, s3, s8
    s_bfe_u32 s8, s2, 0x20003
    s_lshl_b32 s3, s3, 5
    v_lshrrev_b32 v1, 6, v0
    s_nop 0
    v_readfirstlane_b32 s9, v1
    v_mul_u32_u24 v2, 1171, v0
    v_lshrrev_b32 v2, 16, v2
    v_mul_u32_u24 v3, 56, v2
    v_sub_u32 v3, v0, v3
    v_mul_u32_u24 v4, 4682, v3
    v_lshrrev_b32 v4, 16, v4
    v_lshrrev_b32 v5, 1, v4
    v_add_u32 v5, 1, v5
    v_and_b32 v6, 1, v4
    v_lshl_add_u32 v6, v6, 1, -1
    v_mul_i32_i24 v5, v5, v6
    v_add3_u32 v5, v5, v2, s3
    v_mul_i32_i24 v5, 896, v5
    v_lshl_add_u32 v5, v3, 4, v5
    v_xor_b32 v6, v3, v2
    v_lshlrev_b32 v6, 4, v6
    v_lshl_add_u32 v6, v2, 10, v6
    v_xor_b32 v7, 128, v6
    v_and_b32 v8, 15, v0
    v_bfe_u32 v9, v0, 4, 2
    s_mul_i32 s10, s8, 7
    s_add_u32 s10, s10, s9
    v_lshrrev_b32 v10, 3, v8
    v_lshlrev_b32 v10, 1, v10
    v_lshl_add_u32 v13, v9, 2, v10
    v_add_u32 v10, s3, v13
    v_mul_u32_u24 v10, 896, v10
    v_and_b32 v11, 7, v8
    v_lshl_add_u32 v10, v11, 2, v10
    s_lshl_b32 s11, s10, 5
    v_add_u32 v10, s11, v10
    v_add_u32 v11, 14336, v10
    s_mul_i32 s11, s10, 14336
    v_and_b32 v12, 63, v0
    v_lshl_add_u32 v12, v12, 4, s11
    s_waitcnt lgkmcnt(0)
    s_add_u32 s16, s4, 20971520
    s_addc_u32 s17, s5, 0
    s_mov_b32 s18, 1835008
    s_mov_b32 s19, 0x00020000
    buffer_load_dwordx4 v[16:19], v5, s[16:19], 0 offen
    v_add_u32 v5, 7168, v5
    buffer_load_dwordx4 v[20:23], v5, s[16:19], 0 offen
    v_add_u32 v5, 7168, v5
    buffer_load_dwordx4 v[24:27], v5, s[16:19], 0 offen
    v_add_u32 v5, 7168, v5
    buffer_load_dwordx4 v[28:31], v5, s[16:19], 0 offen
    s_add_u32 s22, s4, 42991616
    s_addc_u32 s23, s5, 0
    s_add_u32 s20, s4, 16777216
    s_addc_u32 s21, s5, 0
    s_barrier
    global_load_dwordx4 v[40:43], v12, s[22:23] offset:0
    global_load_dwordx4 v[44:47], v12, s[22:23] offset:1024
    global_load_dwordx4 v[48:51], v12, s[22:23] offset:2048
    global_load_dwordx4 v[52:55], v12, s[22:23] offset:3072
    v_xor_b32 v15, v9, v8
    v_lshlrev_b32 v14, 10, v8
    v_xor_b32 v96, 0, v15
    v_lshl_add_u32 v96, v96, 4, v14
    v_xor_b32 v97, 4, v15
    v_lshl_add_u32 v97, v97, 4, v14
    v_xor_b32 v98, 8, v15
    v_lshl_add_u32 v98, v98, 4, v14
    v_xor_b32 v99, 12, v15
    v_lshl_add_u32 v99, v99, 4, v14
    v_mov_b32 v100, 0
    v_mov_b32 v101, 0
    v_mov_b32 v102, 0
    v_mov_b32 v103, 0
    v_mov_b32 v104, 0
    v_mov_b32 v105, 0
    v_mov_b32 v106, 0
    v_mov_b32 v107, 0
    v_cmp_gt_u32 s[26:27], 8, v8
    s_waitcnt vmcnt(7)
    ds_write_b128 v6, v[16:19] offset:0
    s_waitcnt vmcnt(6)
    ds_write_b128 v7, v[20:23] offset:8192
    s_waitcnt vmcnt(5)
    ds_write_b128 v6, v[24:27] offset:16384
    s_waitcnt vmcnt(4)
    ds_write_b128 v7, v[28:31] offset:24576
    v_add_u32 v12, 4096, v12
    global_load_dwordx4 v[56:59], v12, s[22:23] offset:0
    global_load_dwordx4 v[60:63], v12, s[22:23] offset:1024
    global_load_dwordx4 v[64:67], v12, s[22:23] offset:2048
    global_load_dwordx4 v[68:71], v12, s[22:23] offset:3072
    v_add_u32 v12, 4096, v12
    global_load_dwordx4 v[72:75], v12, s[22:23] offset:0
    global_load_dwordx4 v[76:79], v12, s[22:23] offset:1024
    global_load_dwordx4 v[80:83], v12, s[22:23] offset:2048
    global_load_dwordx4 v[84:87], v12, s[22:23] offset:3072
    v_add_u32 v12, 4096, v12
    global_load_dwordx4 v[88:91], v12, s[22:23] offset:0
    global_load_dwordx4 v[92:95], v12, s[22:23] offset:1024
    global_load_dword v32, v10, s[20:21] offset:0
    global_load_dword v33, v10, s[20:21] offset:896
    global_load_dword v34, v11, s[20:21] offset:0
    global_load_dword v35, v11, s[20:21] offset:896
    s_waitcnt lgkmcnt(0)
    s_barrier
    ds_read_b128 v[108:111], v96 offset:0
    ds_read_b128 v[112:115], v96 offset:16384
    ds_read_b128 v[116:119], v97 offset:0
    ds_read_b128 v[120:123], v97 offset:16384
    ds_read_b128 v[124:127], v98 offset:0
    ds_read_b128 v[128:131], v98 offset:16384
    ds_read_b128 v[132:135], v99 offset:0
    ds_read_b128 v[136:139], v99 offset:16384
    ds_read_b128 v[140:143], v96 offset:256
    ds_read_b128 v[144:147], v96 offset:16640
    ds_read_b128 v[148:151], v97 offset:256
    ds_read_b128 v[152:155], v97 offset:16640
    ds_read_b128 v[156:159], v98 offset:256
    ds_read_b128 v[160:163], v98 offset:16640
    ds_read_b128 v[164:167], v99 offset:256
    ds_read_b128 v[168:171], v99 offset:16640
    ds_read_b128 v[172:175], v96 offset:512
    ds_read_b128 v[176:179], v96 offset:16896
    ds_read_b128 v[180:183], v97 offset:512
    ds_read_b128 v[184:187], v97 offset:16896
    ds_read_b128 v[188:191], v98 offset:512
    ds_read_b128 v[192:195], v98 offset:16896
    ds_read_b128 v[196:199], v99 offset:512
    ds_read_b128 v[200:203], v99 offset:16896
    ds_read_b128 v[204:207], v96 offset:768
    ds_read_b128 v[208:211], v96 offset:17152
    ds_read_b128 v[212:215], v97 offset:768
    ds_read_b128 v[216:219], v97 offset:17152
    s_waitcnt vmcnt(17) lgkmcnt(15)
    v_mfma_f32_16x16x32_bf16 v[100:103], v[108:111], v[40:43], v[100:103]
    v_mfma_f32_16x16x32_bf16 v[104:107], v[112:115], v[40:43], v[104:107]
    s_waitcnt vmcnt(16) lgkmcnt(15)
    v_mfma_f32_16x16x32_bf16 v[100:103], v[116:119], v[44:47], v[100:103]
    v_mfma_f32_16x16x32_bf16 v[104:107], v[120:123], v[44:47], v[104:107]
    s_waitcnt vmcnt(15) lgkmcnt(15)
    v_mfma_f32_16x16x32_bf16 v[100:103], v[124:127], v[48:51], v[100:103]
    v_mfma_f32_16x16x32_bf16 v[104:107], v[128:131], v[48:51], v[104:107]
    s_waitcnt vmcnt(14) lgkmcnt(15)
    v_mfma_f32_16x16x32_bf16 v[100:103], v[132:135], v[52:55], v[100:103]
    v_mfma_f32_16x16x32_bf16 v[104:107], v[136:139], v[52:55], v[104:107]
    s_waitcnt vmcnt(13) lgkmcnt(15)
    v_mfma_f32_16x16x32_bf16 v[100:103], v[140:143], v[56:59], v[100:103]
    v_mfma_f32_16x16x32_bf16 v[104:107], v[144:147], v[56:59], v[104:107]
    s_waitcnt vmcnt(12) lgkmcnt(15)
    v_mfma_f32_16x16x32_bf16 v[100:103], v[148:151], v[60:63], v[100:103]
    v_mfma_f32_16x16x32_bf16 v[104:107], v[152:155], v[60:63], v[104:107]
    s_waitcnt vmcnt(11) lgkmcnt(14)
    v_mfma_f32_16x16x32_bf16 v[100:103], v[156:159], v[64:67], v[100:103]
    v_mfma_f32_16x16x32_bf16 v[104:107], v[160:163], v[64:67], v[104:107]
    s_waitcnt vmcnt(10) lgkmcnt(12)
    v_mfma_f32_16x16x32_bf16 v[100:103], v[164:167], v[68:71], v[100:103]
    v_mfma_f32_16x16x32_bf16 v[104:107], v[168:171], v[68:71], v[104:107]
    s_waitcnt vmcnt(9) lgkmcnt(10)
    v_mfma_f32_16x16x32_bf16 v[100:103], v[172:175], v[72:75], v[100:103]
    v_mfma_f32_16x16x32_bf16 v[104:107], v[176:179], v[72:75], v[104:107]
    s_waitcnt vmcnt(8) lgkmcnt(8)
    v_mfma_f32_16x16x32_bf16 v[100:103], v[180:183], v[76:79], v[100:103]
    v_mfma_f32_16x16x32_bf16 v[104:107], v[184:187], v[76:79], v[104:107]
    s_waitcnt vmcnt(7) lgkmcnt(6)
    v_mfma_f32_16x16x32_bf16 v[100:103], v[188:191], v[80:83], v[100:103]
    v_mfma_f32_16x16x32_bf16 v[104:107], v[192:195], v[80:83], v[104:107]
    s_waitcnt vmcnt(6) lgkmcnt(4)
    v_mfma_f32_16x16x32_bf16 v[100:103], v[196:199], v[84:87], v[100:103]
    v_mfma_f32_16x16x32_bf16 v[104:107], v[200:203], v[84:87], v[104:107]
    s_waitcnt vmcnt(5) lgkmcnt(2)
    v_mfma_f32_16x16x32_bf16 v[100:103], v[204:207], v[88:91], v[100:103]
    v_mfma_f32_16x16x32_bf16 v[104:107], v[208:211], v[88:91], v[104:107]
    s_waitcnt vmcnt(4) lgkmcnt(0)
    v_mfma_f32_16x16x32_bf16 v[100:103], v[212:215], v[92:95], v[100:103]
    v_mfma_f32_16x16x32_bf16 v[104:107], v[216:219], v[92:95], v[104:107]
    s_add_u32 s20, s4, 25165824
    s_addc_u32 s21, s5, 0
    v_mov_b32 v15, 0x3f803f80
    s_waitcnt vmcnt(0)
    s_nop 2
    v_cndmask_b32 v16, v100, v102, s[26:27]
    v_cndmask_b32 v17, v101, v103, s[26:27]
    s_nop 0
    v_mov_b32_dpp v18, v16 row_ror:8 row_mask:0xf bank_mask:0xf
    v_mov_b32_dpp v19, v17 row_ror:8 row_mask:0xf bank_mask:0xf
    v_cndmask_b32 v40, v18, v100, s[26:27]
    v_cndmask_b32 v41, v102, v18, s[26:27]
    v_cndmask_b32 v42, v19, v101, s[26:27]
    v_cndmask_b32 v43, v103, v19, s[26:27]
    v_cndmask_b32 v16, v104, v106, s[26:27]
    v_cndmask_b32 v17, v105, v107, s[26:27]
    s_nop 0
    v_mov_b32_dpp v18, v16 row_ror:8 row_mask:0xf bank_mask:0xf
    v_mov_b32_dpp v19, v17 row_ror:8 row_mask:0xf bank_mask:0xf
    v_cndmask_b32 v44, v18, v104, s[26:27]
    v_cndmask_b32 v45, v106, v18, s[26:27]
    v_cndmask_b32 v46, v19, v105, s[26:27]
    v_cndmask_b32 v47, v107, v19, s[26:27]
    v_lshlrev_b32 v52, 16, v32
    v_and_b32 v53, 0xffff0000, v32
    v_lshlrev_b32 v54, 16, v33
    v_and_b32 v55, 0xffff0000, v33
    v_lshlrev_b32 v56, 16, v34
    v_and_b32 v57, 0xffff0000, v34
    v_lshlrev_b32 v58, 16, v35
    v_and_b32 v59, 0xffff0000, v35
    v_pk_add_f32 v[40:41], v[40:41], v[52:53]
    v_pk_add_f32 v[42:43], v[42:43], v[54:55]
    v_pk_add_f32 v[44:45], v[44:45], v[56:57]
    v_pk_add_f32 v[46:47], v[46:47], v[58:59]
    v_cvt_pk_bf16_f32 v48, v40, v41
    v_cvt_pk_bf16_f32 v49, v42, v43
    v_cvt_pk_bf16_f32 v50, v44, v45
    v_cvt_pk_bf16_f32 v51, v46, v47
    global_store_dword v10, v48, s[20:21] offset:0
    v_dot2_f32_bf16 v56, v48, v15, 0
    v_dot2_f32_bf16 v57, v48, v48, 0
    global_store_dword v10, v49, s[20:21] offset:896
    v_dot2_f32_bf16 v58, v49, v15, 0
    v_dot2_f32_bf16 v59, v49, v49, 0
    global_store_dword v11, v50, s[20:21] offset:0
    v_dot2_f32_bf16 v60, v50, v15, 0
    v_dot2_f32_bf16 v61, v50, v50, 0
    global_store_dword v11, v51, s[20:21] offset:896
    v_dot2_f32_bf16 v62, v51, v15, 0
    v_dot2_f32_bf16 v63, v51, v51, 0
    v_add_f32_dpp v56, v56, v56 quad_perm:[1,0,3,2] row_mask:0xf bank_mask:0xf
    v_add_f32_dpp v57, v57, v57 quad_perm:[1,0,3,2] row_mask:0xf bank_mask:0xf
    v_add_f32_dpp v58, v58, v58 quad_perm:[1,0,3,2] row_mask:0xf bank_mask:0xf
    v_add_f32_dpp v59, v59, v59 quad_perm:[1,0,3,2] row_mask:0xf bank_mask:0xf
    v_add_f32_dpp v60, v60, v60 quad_perm:[1,0,3,2] row_mask:0xf bank_mask:0xf
    v_add_f32_dpp v61, v61, v61 quad_perm:[1,0,3,2] row_mask:0xf bank_mask:0xf
    v_add_f32_dpp v62, v62, v62 quad_perm:[1,0,3,2] row_mask:0xf bank_mask:0xf
    v_add_f32_dpp v63, v63, v63 quad_perm:[1,0,3,2] row_mask:0xf bank_mask:0xf
    v_add_f32_dpp v56, v56, v56 quad_perm:[2,3,0,1] row_mask:0xf bank_mask:0xf
    v_add_f32_dpp v57, v57, v57 quad_perm:[2,3,0,1] row_mask:0xf bank_mask:0xf
    v_add_f32_dpp v58, v58, v58 quad_perm:[2,3,0,1] row_mask:0xf bank_mask:0xf
    v_add_f32_dpp v59, v59, v59 quad_perm:[2,3,0,1] row_mask:0xf bank_mask:0xf
    v_add_f32_dpp v60, v60, v60 quad_perm:[2,3,0,1] row_mask:0xf bank_mask:0xf
    v_add_f32_dpp v61, v61, v61 quad_perm:[2,3,0,1] row_mask:0xf bank_mask:0xf
    v_add_f32_dpp v62, v62, v62 quad_perm:[2,3,0,1] row_mask:0xf bank_mask:0xf
    v_add_f32_dpp v63, v63, v63 quad_perm:[2,3,0,1] row_mask:0xf bank_mask:0xf
    v_add_f32_dpp v56, v56, v56 row_half_mirror row_mask:0xf bank_mask:0xf
    v_add_f32_dpp v57, v57, v57 row_half_mirror row_mask:0xf bank_mask:0xf
    v_add_f32_dpp v58, v58, v58 row_half_mirror row_mask:0xf bank_mask:0xf
    v_add_f32_dpp v59, v59, v59 row_half_mirror row_mask:0xf bank_mask:0xf
    v_add_f32_dpp v60, v60, v60 row_half_mirror row_mask:0xf bank_mask:0xf
    v_add_f32_dpp v61, v61, v61 row_half_mirror row_mask:0xf bank_mask:0xf
    v_add_f32_dpp v62, v62, v62 row_half_mirror row_mask:0xf bank_mask:0xf
    v_add_f32_dpp v63, v63, v63 row_half_mirror row_mask:0xf bank_mask:0xf
    s_lshl_b32 s11, s9, 3
    v_lshl_add_u32 v13, v13, 6, s11
    v_and_b32 v14, 7, v0
    v_cmp_eq_u32 vcc, 0, v14
    s_and_saveexec_b64 s[24:25], vcc
    ds_write_b64 v13, v[56:57] offset:32768
    ds_write_b64 v13, v[58:59] offset:32832
    ds_write_b64 v13, v[60:61] offset:33792
    ds_write_b64 v13, v[62:63] offset:33856
    s_mov_b64 exec, s[24:25]
    s_waitcnt lgkmcnt(0)
    s_barrier
    v_cmp_gt_u32 vcc, 32, v0
    s_and_saveexec_b64 s[24:25], vcc
    s_cbranch_execz K4_DONE
    v_lshlrev_b32 v13, 6, v0
    ds_read_b128 v[16:19], v13 offset:32768
    ds_read_b128 v[20:23], v13 offset:32784
    ds_read_b128 v[24:27], v13 offset:32800
    ds_read_b128 v[28:31], v13 offset:32816
    v_add_u32 v14, s3, v0
    v_lshlrev_b32 v14, 5, v14
    s_lshl_b32 s11, s8, 3
    v_add_u32 v14, s11, v14
    s_add_u32 s20, s4, 32768
    s_addc_u32 s21, s5, 0
    s_waitcnt lgkmcnt(0)
    v_add_f32 v16, v16, v18
    v_add_f32 v17, v17, v19
    v_add_f32 v16, v16, v20
    v_add_f32 v17, v17, v21
    v_add_f32 v16, v16, v22
    v_add_f32 v17, v17, v23
    v_add_f32 v16, v16, v24
    v_add_f32 v17, v17, v25
    v_add_f32 v16, v16, v26
    v_add_f32 v17, v17, v27
    v_add_f32 v16, v16, v28
    v_add_f32 v17, v17, v29
    global_store_dwordx2 v14, v[16:17], s[20:21]
K4_DONE:
K4_END:
    s_endpgm
.globl gemm3_kernel
.p2align 8
.type gemm3_kernel,@function
gemm3_kernel:
    s_cmp_ge_u32 s2, 224
    s_cbranch_scc1 K5_END
    s_load_dwordx2 s[4:5], s[0:1], 144
    s_lshr_b32 s6, s2, 3
    s_cmp_ge_u32 s6, 14
    s_cselect_b32 s7, 1, 0
    s_mul_i32 s8, s7, 14
    s_sub_u32 s8, s6, s8
    s_and_b32 s3, s2, 7
    s_lshl_b32 s3, s3, 1
    s_add_u32 s3, s3, s7
    s_lshl_b32 s3, s3, 7
    v_lshrrev_b32 v1, 6, v0
    s_nop 0
    v_readfirstlane_b32 s9, v1
    v_and_b32 v2, 15, v0
    v_bfe_u32 v3, v0, 4, 2
    v_and_b32 v4, 63, v0
    s_cmp_lt_u32 s9, 4
    s_cbranch_scc1 K5_COMP
    s_sub_u32 s9, s9, 4
    v_lshrrev_b32 v5, 3, v4
    v_and_b32 v6, 6, v5
    v_xor_b32 v6, v6, v4
    v_and_b32 v6, 7, v6
    s_lshl_b32 s10, s9, 4
    s_add_u32 s10, s10, s3
    v_add_u32 v5, s10, v5
    v_mul_u32_u24 v5, 896, v5
    v_lshl_add_u32 v8, v6, 4, v5
    v_add_u32 v9, 7168, v8
    v_add_u32 v10, 57344, v8
    v_add_u32 v11, 57344+7168, v8
    s_lshl_b32 s10, s8, 3
    s_lshl_b32 s11, s9, 1
    s_add_u32 s10, s10, s11
    s_mul_i32 s11, s10, 14336
    v_lshl_add_u32 v12, v4, 4, s11
    v_add_u32 v13, 14336, v12
    s_lshl_b32 s12, s9, 12
    s_lshl_b32 s15, s9, 11
    s_waitcnt lgkmcnt(0)
    s_add_u32 s16, s4, 25165824
    s_addc_u32 s17, s5, 0
    s_mov_b32 s18, 1835008
    s_mov_b32 s19, 0x00020000
    s_add_u32 s28, s4, 44040192
    s_addc_u32 s29, s5, 0
    s_mov_b32 s30, 1605632
    s_mov_b32 s31, 0x00020000
    s_mov_b32 s14, 0
    s_add_u32 m0, s15, 114688
    s_nop 0
    buffer_load_dwordx4 v8, s[16:19], s14 offen lds
    s_add_u32 m0, s15, 115712
    s_nop 0
    buffer_load_dwordx4 v9, s[16:19], s14 offen lds
    s_mov_b32 s13, 0
    s_add_u32 m0, s12, 0
    s_nop 0
    buffer_load_dwordx4 v12, s[28:31], s13 offen offset:0 lds
    s_add_u32 m0, s12, 1024
    s_nop 0
    buffer_load_dwordx4 v13, s[28:31], s13 offen offset:0 lds
    s_add_u32 m0, s12, 1024
    s_nop 0
    buffer_load_dwordx4 v12, s[28:31], s13 offen offset:1024 lds
    s_add_u32 m0, s12, 2048
    s_nop 0
    buffer_load_dwordx4 v13, s[28:31], s13 offen offset:1024 lds
    s_mov_b32 s14, 128
    s_add_u32 m0, s15, 122880
    s_nop 0
    buffer_load_dwordx4 v8, s[16:19], s14 offen lds
    s_add_u32 m0, s15, 123904
    s_nop 0
    buffer_load_dwordx4 v9, s[16:19], s14 offen lds
    s_mov_b32 s13, 2048
    s_add_u32 m0, s12, 16384
    s_nop 0
    buffer_load_dwordx4 v12, s[28:31], s13 offen offset:0 lds
    s_add_u32 m0, s12, 17408
    s_nop 0
    buffer_load_dwordx4 v13, s[28:31], s13 offen offset:0 lds
    s_add_u32 m0, s12, 17408
    s_nop 0
    buffer_load_dwordx4 v12, s[28:31], s13 offen offset:1024 lds
    s_add_u32 m0, s12, 18432
    s_nop 0
    buffer_load_dwordx4 v13, s[28:31], s13 offen offset:1024 lds
    s_mov_b32 s14, 256
    s_add_u32 m0, s15, 131072
    s_nop 0
    buffer_load_dwordx4 v8, s[16:19], s14 offen lds
    s_add_u32 m0, s15, 132096
    s_nop 0
    buffer_load_dwordx4 v9, s[16:19], s14 offen lds
    s_mov_b32 s13, 4096
    s_add_u32 m0, s12, 32768
    s_nop 0
    buffer_load_dwordx4 v12, s[28:31], s13 offen offset:0 lds
    s_add_u32 m0, s12, 33792
    s_nop 0
    buffer_load_dwordx4 v13, s[28:31], s13 offen offset:0 lds
    s_add_u32 m0, s12, 33792
    s_nop 0
    buffer_load_dwordx4 v12, s[28:31], s13 offen offset:1024 lds
    s_add_u32 m0, s12, 34816
    s_nop 0
    buffer_load_dwordx4 v13, s[28:31], s13 offen offset:1024 lds
    s_mov_b32 s14, 384
    s_add_u32 m0, s15, 139264
    s_nop 0
    buffer_load_dwordx4 v8, s[16:19], s14 offen lds
    s_add_u32 m0, s15, 140288
    s_nop 0
    buffer_load_dwordx4 v9, s[16:19], s14 offen lds
    s_mov_b32 s13, 6144
    s_add_u32 m0, s12, 49152
    s_nop 0
    buffer_load_dwordx4 v12, s[28:31], s13 offen offset:0 lds
    s_add_u32 m0, s12, 50176
    s_nop 0
    buffer_load_dwordx4 v13, s[28:31], s13 offen offset:0 lds
    s_add_u32 m0, s12, 50176
    s_nop 0
    buffer_load_dwordx4 v12, s[28:31], s13 offen offset:1024 lds
    s_add_u32 m0, s12, 51200
    s_nop 0
    buffer_load_dwordx4 v13, s[28:31], s13 offen offset:1024 lds
    s_waitcnt vmcnt(18)
    s_barrier
    s_mov_b32 s14, 512
    s_add_u32 m0, s15, 147456
    s_nop 0
    buffer_load_dwordx4 v8, s[16:19], s14 offen lds
    s_add_u32 m0, s15, 148480
    s_nop 0
    buffer_load_dwordx4 v9, s[16:19], s14 offen lds
    s_mov_b32 s13, 8192
    s_add_u32 m0, s12, 65536
    s_nop 0
    buffer_load_dwordx4 v12, s[28:31], s13 offen offset:0 lds
    s_add_u32 m0, s12, 66560
    s_nop 0
    buffer_load_dwordx4 v13, s[28:31], s13 offen offset:0 lds
    s_add_u32 m0, s12, 66560
    s_nop 0
    buffer_load_dwordx4 v12, s[28:31], s13 offen offset:1024 lds
    s_add_u32 m0, s12, 67584
    s_nop 0
    buffer_load_dwordx4 v13, s[28:31], s13 offen offset:1024 lds
    s_waitcnt vmcnt(18)
    s_barrier
    s_mov_b32 s14, 640
    s_add_u32 m0, s15, 114688
    s_nop 0
    buffer_load_dwordx4 v8, s[16:19], s14 offen lds
    s_add_u32 m0, s15, 115712
    s_nop 0
    buffer_load_dwordx4 v9, s[16:19], s14 offen lds
    s_mov_b32 s13, 10240
    s_add_u32 m0, s12, 81920
    s_nop 0
    buffer_load_dwordx4 v12, s[28:31], s13 offen offset:0 lds
    s_add_u32 m0, s12, 82944
    s_nop 0
    buffer_load_dwordx4 v13, s[28:31], s13 offen offset:0 lds
    s_add_u32 m0, s12, 82944
    s_nop 0
    buffer_load_dwordx4 v12, s[28:31], s13 offen offset:1024 lds
    s_add_u32 m0, s12, 83968
    s_nop 0
    buffer_load_dwordx4 v13, s[28:31], s13 offen offset:1024 lds
    s_waitcnt vmcnt(18)
    s_barrier
    s_mov_b32 s14, 768
    s_add_u32 m0, s15, 122880
    s_nop 0
    buffer_load_dwordx4 v8, s[16:19], s14 offen lds
    s_add_u32 m0, s15, 123904
    s_nop 0
    buffer_load_dwordx4 v9, s[16:19], s14 offen lds
    s_mov_b32 s13, 12288
    s_add_u32 m0, s12, 98304
    s_nop 0
    buffer_load_dwordx4 v12, s[28:31], s13 offen offset:0 lds
    s_add_u32 m0, s12, 99328
    s_nop 0
    buffer_load_dwordx4 v13, s[28:31], s13 offen offset:0 lds
    s_add_u32 m0, s12, 99328
    s_nop 0
    buffer_load_dwordx4 v12, s[28:31], s13 offen offset:1024 lds
    s_add_u32 m0, s12, 100352
    s_nop 0
    buffer_load_dwordx4 v13, s[28:31], s13 offen offset:1024 lds
    s_waitcnt vmcnt(18)
    s_barrier
    s_mov_b32 s14, 0
    s_add_u32 m0, s15, 131072
    s_nop 0
    buffer_load_dwordx4 v10, s[16:19], s14 offen lds
    s_add_u32 m0, s15, 132096
    s_nop 0
    buffer_load_dwordx4 v11, s[16:19], s14 offen lds
    s_waitcnt vmcnt(14)
    s_barrier
    s_mov_b32 s14, 128
    s_add_u32 m0, s15, 139264
    s_nop 0
    buffer_load_dwordx4 v10, s[16:19], s14 offen lds
    s_add_u32 m0, s15, 140288
    s_nop 0
    buffer_load_dwordx4 v11, s[16:19], s14 offen lds
    s_waitcnt vmcnt(10)
    s_barrier
    s_mov_b32 s14, 256
    s_add_u32 m0, s15, 147456
    s_nop 0
    buffer_load_dwordx4 v10, s[16:19], s14 offen lds
    s_add_u32 m0, s15, 148480
    s_nop 0
    buffer_load_dwordx4 v11, s[16:19], s14 offen lds
    s_waitcnt vmcnt(6)
    s_barrier
    s_mov_b32 s14, 384
    s_add_u32 m0, s15, 114688
    s_nop 0
    buffer_load_dwordx4 v10, s[16:19], s14 offen lds
    s_add_u32 m0, s15, 115712
    s_nop 0
    buffer_load_dwordx4 v11, s[16:19], s14 offen lds
    s_waitcnt vmcnt(6)
    s_barrier
    s_mov_b32 s14, 512
    s_add_u32 m0, s15, 122880
    s_nop 0
    buffer_load_dwordx4 v10, s[16:19], s14 offen lds
    s_add_u32 m0, s15, 123904
    s_nop 0
    buffer_load_dwordx4 v11, s[16:19], s14 offen lds
    s_waitcnt vmcnt(6)
    s_barrier
    s_mov_b32 s14, 640
    s_add_u32 m0, s15, 131072
    s_nop 0
    buffer_load_dwordx4 v10, s[16:19], s14 offen lds
    s_add_u32 m0, s15, 132096
    s_nop 0
    buffer_load_dwordx4 v11, s[16:19], s14 offen lds
    s_waitcnt vmcnt(6)
    s_barrier
    s_mov_b32 s14, 768
    s_add_u32 m0, s15, 139264
    s_nop 0
    buffer_load_dwordx4 v10, s[16:19], s14 offen lds
    s_add_u32 m0, s15, 140288
    s_nop 0
    buffer_load_dwordx4 v11, s[16:19], s14 offen lds
    s_waitcnt vmcnt(6)
    s_barrier
    s_waitcnt vmcnt(4)
    s_barrier
    s_waitcnt vmcnt(2)
    s_barrier
    s_waitcnt vmcnt(0)
    s_barrier
    s_endpgm
K5_COMP:
    s_lshl_b32 s10, s8, 3
    s_lshl_b32 s11, s9, 1
    s_add_u32 s10, s10, s11
    s_lshl_b32 s11, s10, 6
    v_lshl_add_u32 v8, v2, 3, s11
    v_add_u32 v9, s3, v0
    v_lshlrev_b32 v9, 5, v9
    v_cmp_gt_u32 vcc, 128, v0
    v_mov_b32 v10, 0x80000000
    s_nop 0
    v_cndmask_b32 v9, v10, v9, vcc
    s_waitcnt lgkmcnt(0)
    s_add_u32 s20, s4, 32768
    s_addc_u32 s21, s5, 0
    s_mov_b32 s22, 65536
    s_mov_b32 s23, 0x00020000
    buffer_load_dwordx4 v[16:19], v9, s[20:23], 0 offen
    buffer_load_dwordx4 v[20:23], v9, s[20:23], 0 offen offset:16
    s_add_u32 s24, s4, 24576
    s_addc_u32 s25, s5, 0
    global_load_dwordx2 v[24:25], v8, s[24:25]
    v_and_b32 v10, 6, v2
    v_xor_b32 v10, v10, v3
    v_lshlrev_b32 v10, 4, v10
    v_lshl_add_u32 v10, v2, 7, v10
    v_add_u32 v10, 114688, v10
    v_xor_b32 v11, 64, v10
    s_lshl_b32 s11, s9, 12
    v_lshl_add_u32 v14, v4, 4, s11
    v_add_u32 v15, 65536, v14
    v_lshl_add_u32 v12, v3, 2, s3
    v_mul_u32_u24 v12, 3584, v12
    v_lshl_add_u32 v12, v2, 2, v12
    s_lshl_b32 s11, s10, 5
    v_add_u32 v12, s11, v12
    v_add_u32 v13, 7168, v12
    s_add_u32 s24, s4, 29360128
    s_addc_u32 s25, s5, 0
    v_mov_b32 v26, 0xbdd2d3e8
    v_mov_b32 v27, 0xbdd2d3e8
    v_mov_b32 v28, 0xc0135761
    v_mov_b32 v29, 0xc0135761
    v_mov_b32 v30, 0x3f800000
    v_mov_b32 v31, 0x3f800000
    v_mov_b32 v32, 0
    v_mov_b32 v33, 0
    v_mov_b32 v34, 0
    v_mov_b32 v35, 0
    v_mov_b32 v36, 0
    v_mov_b32 v37, 0
    v_mov_b32 v38, 0
    v_mov_b32 v39, 0
    v_mov_b32 v40, 0
    v_mov_b32 v41, 0
    v_mov_b32 v42, 0
    v_mov_b32 v43, 0
    v_mov_b32 v44, 0
    v_mov_b32 v45, 0
    v_mov_b32 v46, 0
    v_mov_b32 v47, 0
    v_mov_b32 v48, 0
    v_mov_b32 v49, 0
    v_mov_b32 v50, 0
    v_mov_b32 v51, 0
    v_mov_b32 v52, 0
    v_mov_b32 v53, 0
    v_mov_b32 v54, 0
    v_mov_b32 v55, 0
    v_mov_b32 v56, 0
    v_mov_b32 v57, 0
    v_mov_b32 v58, 0
    v_mov_b32 v59, 0
    v_mov_b32 v60, 0
    v_mov_b32 v61, 0
    v_mov_b32 v62, 0
    v_mov_b32 v63, 0
    v_mov_b32 v64, 0
    v_mov_b32 v65, 0
    v_mov_b32 v66, 0
    v_mov_b32 v67, 0
    v_mov_b32 v68, 0
    v_mov_b32 v69, 0
    v_mov_b32 v70, 0
    v_mov_b32 v71, 0
    v_mov_b32 v72, 0
    v_mov_b32 v73, 0
    v_mov_b32 v74, 0
    v_mov_b32 v75, 0
    v_mov_b32 v76, 0
    v_mov_b32 v77, 0
    v_mov_b32 v78, 0
    v_mov_b32 v79, 0
    v_mov_b32 v80, 0
    v_mov_b32 v81, 0
    v_mov_b32 v82, 0
    v_mov_b32 v83, 0
    v_mov_b32 v84, 0
    v_mov_b32 v85, 0
    v_mov_b32 v86, 0
    v_mov_b32 v87, 0
    v_mov_b32 v88, 0
    v_mov_b32 v89, 0
    v_mov_b32 v90, 0
    v_mov_b32 v91, 0
    v_mov_b32 v92, 0
    v_mov_b32 v93, 0
    v_mov_b32 v94, 0
    v_mov_b32 v95, 0
    s_barrier
    ds_read_b128 v[128:131], v14 offset:0
    ds_read_b128 v[132:135], v14 offset:1024
    ds_read_b128 v[96:99], v10 offset:0
    ds_read_b128 v[100:103], v10 offset:2048
    ds_read_b128 v[104:107], v10 offset:4096
    ds_read_b128 v[108:111], v10 offset:6144
    ds_read_b128 v[136:139], v14 offset:2048
    ds_read_b128 v[140:143], v14 offset:3072
    ds_read_b128 v[112:115], v11 offset:0
    ds_read_b128 v[116:119], v11 offset:2048
    ds_read_b128 v[120:123], v11 offset:4096
    ds_read_b128 v[124:127], v11 offset:6144
    s_waitcnt lgkmcnt(0)
    s_barrier
    v_mfma_f32_16x16x32_bf16 v[32:35], v[96:99], v[128:131], v[32:35]
    ds_read_b128 v[176:179], v14 offset:16384
    v_mfma_f32_16x16x32_bf16 v[36:39], v[96:99], v[132:135], v[36:39]
    ds_read_b128 v[180:183], v14 offset:17408
    v_mfma_f32_16x16x32_bf16 v[40:43], v[100:103], v[128:131], v[40:43]
    ds_read_b128 v[144:147], v10 offset:8192
    v_mfma_f32_16x16x32_bf16 v[44:47], v[100:103], v[132:135], v[44:47]
    ds_read_b128 v[148:151], v10 offset:10240
    v_mfma_f32_16x16x32_bf16 v[48:51], v[104:107], v[128:131], v[48:51]
    ds_read_b128 v[152:155], v10 offset:12288
    v_mfma_f32_16x16x32_bf16 v[52:55], v[104:107], v[132:135], v[52:55]
    ds_read_b128 v[156:159], v10 offset:14336
    v_mfma_f32_16x16x32_bf16 v[56:59], v[108:111], v[128:131], v[56:59]
    ds_read_b128 v[184:187], v14 offset:18432
    v_mfma_f32_16x16x32_bf16 v[60:63], v[108:111], v[132:135], v[60:63]
    ds_read_b128 v[188:191], v14 offset:19456
    v_mfma_f32_16x16x32_bf16 v[32:35], v[112:115], v[136:139], v[32:35]
    ds_read_b128 v[160:163], v11 offset:8192
    v_mfma_f32_16x16x32_bf16 v[36:39], v[112:115], v[140:143], v[36:39]
    ds_read_b128 v[164:167], v11 offset:10240
    v_mfma_f32_16x16x32_bf16 v[40:43], v[116:119], v[136:139], v[40:43]
    ds_read_b128 v[168:171], v11 offset:12288
    v_mfma_f32_16x16x32_bf16 v[44:47], v[116:119], v[140:143], v[44:47]
    ds_read_b128 v[172:175], v11 offset:14336
    v_mfma_f32_16x16x32_bf16 v[48:51], v[120:123], v[136:139], v[48:51]
    v_mfma_f32_16x16x32_bf16 v[52:55], v[120:123], v[140:143], v[52:55]
    v_mfma_f32_16x16x32_bf16 v[56:59], v[124:127], v[136:139], v[56:59]
    v_mfma_f32_16x16x32_bf16 v[60:63], v[124:127], v[140:143], v[60:63]
    s_waitcnt lgkmcnt(0)
    s_barrier
    v_mfma_f32_16x16x32_bf16 v[32:35], v[144:147], v[176:179], v[32:35]
    ds_read_b128 v[128:131], v14 offset:32768
    v_mfma_f32_16x16x32_bf16 v[36:39], v[144:147], v[180:183], v[36:39]
    ds_read_b128 v[132:135], v14 offset:33792
    v_mfma_f32_16x16x32_bf16 v[40:43], v[148:151], v[176:179], v[40:43]
    ds_read_b128 v[96:99], v10 offset:16384
    v_mfma_f32_16x16x32_bf16 v[44:47], v[148:151], v[180:183], v[44:47]
    ds_read_b128 v[100:103], v10 offset:18432
    v_mfma_f32_16x16x32_bf16 v[48:51], v[152:155], v[176:179], v[48:51]
    ds_read_b128 v[104:107], v10 offset:20480
    v_mfma_f32_16x16x32_bf16 v[52:55], v[152:155], v[180:183], v[52:55]
    ds_read_b128 v[108:111], v10 offset:22528
    v_mfma_f32_16x16x32_bf16 v[56:59], v[156:159], v[176:179], v[56:59]
    ds_read_b128 v[136:139], v14 offset:34816
    v_mfma_f32_16x16x32_bf16 v[60:63], v[156:159], v[180:183], v[60:63]
    ds_read_b128 v[140:143], v14 offset:35840
    v_mfma_f32_16x16x32_bf16 v[32:35], v[160:163], v[184:187], v[32:35]
    ds_read_b128 v[112:115], v11 offset:16384
    v_mfma_f32_16x16x32_bf16 v[36:39], v[160:163], v[188:191], v[36:39]
    ds_read_b128 v[116:119], v11 offset:18432
    v_mfma_f32_16x16x32_bf16 v[40:43], v[164:167], v[184:187], v[40:43]
    ds_read_b128 v[120:123], v11 offset:20480
    v_mfma_f32_16x16x32_bf16 v[44:47], v[164:167], v[188:191], v[44:47]
    ds_read_b128 v[124:127], v11 offset:22528
    v_mfma_f32_16x16x32_bf16 v[48:51], v[168:171], v[184:187], v[48:51]
    v_mfma_f32_16x16x32_bf16 v[52:55], v[168:171], v[188:191], v[52:55]
    v_mfma_f32_16x16x32_bf16 v[56:59], v[172:175], v[184:187], v[56:59]
    v_mfma_f32_16x16x32_bf16 v[60:63], v[172:175], v[188:191], v[60:63]
    s_waitcnt lgkmcnt(0)
    s_barrier
    v_mfma_f32_16x16x32_bf16 v[32:35], v[96:99], v[128:131], v[32:35]
    ds_read_b128 v[176:179], v14 offset:49152
    v_mfma_f32_16x16x32_bf16 v[36:39], v[96:99], v[132:135], v[36:39]
    ds_read_b128 v[180:183], v14 offset:50176
    v_mfma_f32_16x16x32_bf16 v[40:43], v[100:103], v[128:131], v[40:43]
    ds_read_b128 v[144:147], v10 offset:24576
    v_mfma_f32_16x16x32_bf16 v[44:47], v[100:103], v[132:135], v[44:47]
    ds_read_b128 v[148:151], v10 offset:26624
    v_mfma_f32_16x16x32_bf16 v[48:51], v[104:107], v[128:131], v[48:51]
    ds_read_b128 v[152:155], v10 offset:28672
    v_mfma_f32_16x16x32_bf16 v[52:55], v[104:107], v[132:135], v[52:55]
    ds_read_b128 v[156:159], v10 offset:30720
    v_mfma_f32_16x16x32_bf16 v[56:59], v[108:111], v[128:131], v[56:59]
    ds_read_b128 v[184:187], v14 offset:51200
    v_mfma_f32_16x16x32_bf16 v[60:63], v[108:111], v[132:135], v[60:63]
    ds_read_b128 v[188:191], v14 offset:52224
    v_mfma_f32_16x16x32_bf16 v[32:35], v[112:115], v[136:139], v[32:35]
    ds_read_b128 v[160:163], v11 offset:24576
    v_mfma_f32_16x16x32_bf16 v[36:39], v[112:115], v[140:143], v[36:39]
    ds_read_b128 v[164:167], v11 offset:26624
    v_mfma_f32_16x16x32_bf16 v[40:43], v[116:119], v[136:139], v[40:43]
    ds_read_b128 v[168:171], v11 offset:28672
    v_mfma_f32_16x16x32_bf16 v[44:47], v[116:119], v[140:143], v[44:47]
    ds_read_b128 v[172:175], v11 offset:30720
    v_mfma_f32_16x16x32_bf16 v[48:51], v[120:123], v[136:139], v[48:51]
    v_mfma_f32_16x16x32_bf16 v[52:55], v[120:123], v[140:143], v[52:55]
    v_mfma_f32_16x16x32_bf16 v[56:59], v[124:127], v[136:139], v[56:59]
    v_mfma_f32_16x16x32_bf16 v[60:63], v[124:127], v[140:143], v[60:63]
    s_waitcnt vmcnt(0)
    v_add_f32 v16, v16, v18
    v_add_f32 v17, v17, v19
    v_add_f32 v16, v16, v20
    v_add_f32 v17, v17, v21
    v_add_f32 v16, v16, v22
    v_add_f32 v17, v17, v23
    v_mul_f32 v16, 0x3b124925, v16
    v_mul_f32 v17, 0x3b124925, v17
    v_fma_f32 v17, -v16, v16, v17
    v_max_f32 v17, 0, v17
    v_cvt_pk_bf16_f32 v224, v16, v16
    v_lshlrev_b32 v224, 16, v224
    v_cvt_pk_bf16_f32 v226, v17, v17
    v_lshlrev_b32 v226, 16, v226
    v_add_f32 v226, 0x3727c5ac, v226
    v_cvt_pk_bf16_f32 v226, v226, v226
    v_lshlrev_b32 v226, 16, v226
    v_sqrt_f32 v226, v226
    s_nop 0
    v_cvt_pk_bf16_f32 v226, v226, v226
    v_lshlrev_b32 v226, 16, v226
    v_rcp_f32 v225, v226
    v_sub_f32 v224, 0, v224
    v_lshlrev_b32 v9, 2, v0
    s_and_saveexec_b64 s[26:27], vcc
    v_add_u32 v9, 155648, v9
    ds_write_b32 v9, v224
    ds_write_b32 v9, v225 offset:512
    s_mov_b64 exec, s[26:27]
    v_lshlrev_b32 v9, 4, v3
    v_add_u32 v9, 155648, v9
    v_mov_b32 v20, v24
    v_mov_b32 v21, v24
    v_mov_b32 v22, v25
    v_mov_b32 v23, v25
    s_waitcnt lgkmcnt(0)
    s_barrier
    v_mfma_f32_16x16x32_bf16 v[32:35], v[144:147], v[176:179], v[32:35]
    ds_read_b128 v[128:131], v15 offset:0
    v_mfma_f32_16x16x32_bf16 v[36:39], v[144:147], v[180:183], v[36:39]
    ds_read_b128 v[132:135], v15 offset:1024
    v_mfma_f32_16x16x32_bf16 v[40:43], v[148:151], v[176:179], v[40:43]
    ds_read_b128 v[96:99], v10 offset:32768
    v_mfma_f32_16x16x32_bf16 v[44:47], v[148:151], v[180:183], v[44:47]
    ds_read_b128 v[100:103], v10 offset:34816
    v_mfma_f32_16x16x32_bf16 v[48:51], v[152:155], v[176:179], v[48:51]
    ds_read_b128 v[104:107], v10 offset:36864
    v_mfma_f32_16x16x32_bf16 v[52:55], v[152:155], v[180:183], v[52:55]
    ds_read_b128 v[108:111], v10 offset:38912
    v_mfma_f32_16x16x32_bf16 v[56:59], v[156:159], v[176:179], v[56:59]
    ds_read_b128 v[136:139], v15 offset:2048
    v_mfma_f32_16x16x32_bf16 v[60:63], v[156:159], v[180:183], v[60:63]
    ds_read_b128 v[140:143], v15 offset:3072
    v_mfma_f32_16x16x32_bf16 v[32:35], v[160:163], v[184:187], v[32:35]
    ds_read_b128 v[112:115], v11 offset:32768
    v_mfma_f32_16x16x32_bf16 v[36:39], v[160:163], v[188:191], v[36:39]
    ds_read_b128 v[116:119], v11 offset:34816
    v_mfma_f32_16x16x32_bf16 v[40:43], v[164:167], v[184:187], v[40:43]
    ds_read_b128 v[120:123], v11 offset:36864
    v_mfma_f32_16x16x32_bf16 v[44:47], v[164:167], v[188:191], v[44:47]
    ds_read_b128 v[124:127], v11 offset:38912
    v_mfma_f32_16x16x32_bf16 v[48:51], v[168:171], v[184:187], v[48:51]
    v_mfma_f32_16x16x32_bf16 v[52:55], v[168:171], v[188:191], v[52:55]
    v_mfma_f32_16x16x32_bf16 v[56:59], v[172:175], v[184:187], v[56:59]
    v_mfma_f32_16x16x32_bf16 v[60:63], v[172:175], v[188:191], v[60:63]
    s_waitcnt lgkmcnt(0)
    s_barrier
    v_mfma_f32_16x16x32_bf16 v[32:35], v[96:99], v[128:131], v[32:35]
    ds_read_b128 v[176:179], v15 offset:16384
    v_mfma_f32_16x16x32_bf16 v[36:39], v[96:99], v[132:135], v[36:39]
    ds_read_b128 v[180:183], v15 offset:17408
    v_mfma_f32_16x16x32_bf16 v[40:43], v[100:103], v[128:131], v[40:43]
    ds_read_b128 v[144:147], v10 offset:0
    v_mfma_f32_16x16x32_bf16 v[44:47], v[100:103], v[132:135], v[44:47]
    ds_read_b128 v[148:151], v10 offset:2048
    v_mfma_f32_16x16x32_bf16 v[48:51], v[104:107], v[128:131], v[48:51]
    ds_read_b128 v[152:155], v10 offset:4096
    v_mfma_f32_16x16x32_bf16 v[52:55], v[104:107], v[132:135], v[52:55]
    ds_read_b128 v[156:159], v10 offset:6144
    v_mfma_f32_16x16x32_bf16 v[56:59], v[108:111], v[128:131], v[56:59]
    ds_read_b128 v[184:187], v15 offset:18432
    v_mfma_f32_16x16x32_bf16 v[60:63], v[108:111], v[132:135], v[60:63]
    ds_read_b128 v[188:191], v15 offset:19456
    v_mfma_f32_16x16x32_bf16 v[32:35], v[112:115], v[136:139], v[32:35]
    ds_read_b128 v[160:163], v11 offset:0
    v_mfma_f32_16x16x32_bf16 v[36:39], v[112:115], v[140:143], v[36:39]
    ds_read_b128 v[164:167], v11 offset:2048
    v_mfma_f32_16x16x32_bf16 v[40:43], v[116:119], v[136:139], v[40:43]
    ds_read_b128 v[168:171], v11 offset:4096
    v_mfma_f32_16x16x32_bf16 v[44:47], v[116:119], v[140:143], v[44:47]
    ds_read_b128 v[172:175], v11 offset:6144
    v_mfma_f32_16x16x32_bf16 v[48:51], v[120:123], v[136:139], v[48:51]
    v_mfma_f32_16x16x32_bf16 v[52:55], v[120:123], v[140:143], v[52:55]
    v_mfma_f32_16x16x32_bf16 v[56:59], v[124:127], v[136:139], v[56:59]
    v_mfma_f32_16x16x32_bf16 v[60:63], v[124:127], v[140:143], v[60:63]
    s_waitcnt lgkmcnt(0)
    s_barrier
    ds_read_b128 v[192:195], v9 offset:0
    ds_read_b128 v[196:199], v9 offset:512
    ds_read_b128 v[200:203], v9 offset:64
    ds_read_b128 v[204:207], v9 offset:576
    ds_read_b128 v[208:211], v9 offset:128
    ds_read_b128 v[212:215], v9 offset:640
    ds_read_b128 v[216:219], v9 offset:192
    ds_read_b128 v[220:223], v9 offset:704
    v_mfma_f32_16x16x32_bf16 v[32:35], v[144:147], v[176:179], v[32:35]
    ds_read_b128 v[128:131], v15 offset:32768
    v_mfma_f32_16x16x32_bf16 v[36:39], v[144:147], v[180:183], v[36:39]
    ds_read_b128 v[132:135], v15 offset:33792
    v_mfma_f32_16x16x32_bf16 v[40:43], v[148:151], v[176:179], v[40:43]
    ds_read_b128 v[96:99], v10 offset:8192
    v_mfma_f32_16x16x32_bf16 v[44:47], v[148:151], v[180:183], v[44:47]
    ds_read_b128 v[100:103], v10 offset:10240
    v_mfma_f32_16x16x32_bf16 v[48:51], v[152:155], v[176:179], v[48:51]
    ds_read_b128 v[104:107], v10 offset:12288
    v_mfma_f32_16x16x32_bf16 v[52:55], v[152:155], v[180:183], v[52:55]
    ds_read_b128 v[108:111], v10 offset:14336
    v_mfma_f32_16x16x32_bf16 v[56:59], v[156:159], v[176:179], v[56:59]
    ds_read_b128 v[136:139], v15 offset:34816
    v_mfma_f32_16x16x32_bf16 v[60:63], v[156:159], v[180:183], v[60:63]
    ds_read_b128 v[140:143], v15 offset:35840
    v_mfma_f32_16x16x32_bf16 v[32:35], v[160:163], v[184:187], v[32:35]
    ds_read_b128 v[112:115], v11 offset:8192
    v_mfma_f32_16x16x32_bf16 v[36:39], v[160:163], v[188:191], v[36:39]
    ds_read_b128 v[116:119], v11 offset:10240
    v_mfma_f32_16x16x32_bf16 v[40:43], v[164:167], v[184:187], v[40:43]
    ds_read_b128 v[120:123], v11 offset:12288
    v_mfma_f32_16x16x32_bf16 v[44:47], v[164:167], v[188:191], v[44:47]
    ds_read_b128 v[124:127], v11 offset:14336
    v_mfma_f32_16x16x32_bf16 v[48:51], v[168:171], v[184:187], v[48:51]
    v_mfma_f32_16x16x32_bf16 v[52:55], v[168:171], v[188:191], v[52:55]
    v_mfma_f32_16x16x32_bf16 v[56:59], v[172:175], v[184:187], v[56:59]
    v_mfma_f32_16x16x32_bf16 v[60:63], v[172:175], v[188:191], v[60:63]
    s_waitcnt lgkmcnt(0)
    s_barrier
    v_mfma_f32_16x16x32_bf16 v[32:35], v[96:99], v[128:131], v[32:35]
    ds_read_b128 v[176:179], v14 offset:0
    v_mfma_f32_16x16x32_bf16 v[36:39], v[96:99], v[132:135], v[36:39]
    ds_read_b128 v[180:183], v14 offset:1024
    v_mfma_f32_16x16x32_bf16 v[40:43], v[100:103], v[128:131], v[40:43]
    ds_read_b128 v[144:147], v10 offset:16384
    v_mfma_f32_16x16x32_bf16 v[44:47], v[100:103], v[132:135], v[44:47]
    ds_read_b128 v[148:151], v10 offset:18432
    v_mfma_f32_16x16x32_bf16 v[48:51], v[104:107], v[128:131], v[48:51]
    ds_read_b128 v[152:155], v10 offset:20480
    v_mfma_f32_16x16x32_bf16 v[52:55], v[104:107], v[132:135], v[52:55]
    ds_read_b128 v[156:159], v10 offset:22528
    v_mfma_f32_16x16x32_bf16 v[56:59], v[108:111], v[128:131], v[56:59]
    ds_read_b128 v[184:187], v14 offset:2048
    v_mfma_f32_16x16x32_bf16 v[60:63], v[108:111], v[132:135], v[60:63]
    ds_read_b128 v[188:191], v14 offset:3072
    v_mfma_f32_16x16x32_bf16 v[32:35], v[112:115], v[136:139], v[32:35]
    ds_read_b128 v[160:163], v11 offset:16384
    v_mfma_f32_16x16x32_bf16 v[36:39], v[112:115], v[140:143], v[36:39]
    ds_read_b128 v[164:167], v11 offset:18432
    v_mfma_f32_16x16x32_bf16 v[40:43], v[116:119], v[136:139], v[40:43]
    ds_read_b128 v[168:171], v11 offset:20480
    v_mfma_f32_16x16x32_bf16 v[44:47], v[116:119], v[140:143], v[44:47]
    ds_read_b128 v[172:175], v11 offset:22528
    v_mfma_f32_16x16x32_bf16 v[48:51], v[120:123], v[136:139], v[48:51]
    v_mfma_f32_16x16x32_bf16 v[52:55], v[120:123], v[140:143], v[52:55]
    v_mfma_f32_16x16x32_bf16 v[56:59], v[124:127], v[136:139], v[56:59]
    v_mfma_f32_16x16x32_bf16 v[60:63], v[124:127], v[140:143], v[60:63]
    s_waitcnt lgkmcnt(0)
    s_barrier
    v_mfma_f32_16x16x32_bf16 v[64:67], v[144:147], v[176:179], v[64:67]
    ds_read_b128 v[128:131], v14 offset:16384
    v_mfma_f32_16x16x32_bf16 v[68:71], v[144:147], v[180:183], v[68:71]
    ds_read_b128 v[132:135], v14 offset:17408
    v_mfma_f32_16x16x32_bf16 v[72:75], v[148:151], v[176:179], v[72:75]
    ds_read_b128 v[96:99], v10 offset:24576
    v_mfma_f32_16x16x32_bf16 v[76:79], v[148:151], v[180:183], v[76:79]
    ds_read_b128 v[100:103], v10 offset:26624
    v_mfma_f32_16x16x32_bf16 v[80:83], v[152:155], v[176:179], v[80:83]
    ds_read_b128 v[104:107], v10 offset:28672
    v_fma_f32 v32, v192, v20, v32
    v_fma_f32 v33, v193, v21, v33
    v_mfma_f32_16x16x32_bf16 v[84:87], v[152:155], v[180:183], v[84:87]
    ds_read_b128 v[108:111], v10 offset:30720
    v_fma_f32 v34, v194, v20, v34
    v_fma_f32 v35, v195, v21, v35
    v_mfma_f32_16x16x32_bf16 v[88:91], v[156:159], v[176:179], v[88:91]
    ds_read_b128 v[136:139], v14 offset:18432
    v_fma_f32 v36, v192, v22, v36
    v_fma_f32 v37, v193, v23, v37
    v_mfma_f32_16x16x32_bf16 v[92:95], v[156:159], v[180:183], v[92:95]
    ds_read_b128 v[140:143], v14 offset:19456
    v_fma_f32 v38, v194, v22, v38
    v_fma_f32 v39, v195, v23, v39
    v_mfma_f32_16x16x32_bf16 v[64:67], v[160:163], v[184:187], v[64:67]
    ds_read_b128 v[112:115], v11 offset:24576
    v_mul_f32 v32, v32, v196
    v_mul_f32 v33, v33, v197
    v_mfma_f32_16x16x32_bf16 v[68:71], v[160:163], v[188:191], v[68:71]
    ds_read_b128 v[116:119], v11 offset:26624
    v_mul_f32 v34, v34, v198
    v_mul_f32 v35, v35, v199
    v_mfma_f32_16x16x32_bf16 v[72:75], v[164:167], v[184:187], v[72:75]
    ds_read_b128 v[120:123], v11 offset:28672
    v_mul_f32 v36, v36, v196
    v_mul_f32 v37, v37, v197
    v_mfma_f32_16x16x32_bf16 v[76:79], v[164:167], v[188:191], v[76:79]
    ds_read_b128 v[124:127], v11 offset:30720
    v_mul_f32 v38, v38, v198
    v_mul_f32 v39, v39, v199
    v_mfma_f32_16x16x32_bf16 v[80:83], v[168:171], v[184:187], v[80:83]
    v_mul_f32 v224, v32, v32
    v_mul_f32 v225, v33, v33
    v_mfma_f32_16x16x32_bf16 v[84:87], v[168:171], v[188:191], v[84:87]
    v_mul_f32 v226, v34, v34
    v_mul_f32 v227, v35, v35
    v_mfma_f32_16x16x32_bf16 v[88:91], v[172:175], v[184:187], v[88:91]
    v_mul_f32 v228, v36, v36
    v_mul_f32 v229, v37, v37
    v_mfma_f32_16x16x32_bf16 v[92:95], v[172:175], v[188:191], v[92:95]
    v_mul_f32 v230, v38, v38
    v_mul_f32 v231, v39, v39
    s_waitcnt lgkmcnt(0)
    s_barrier
    v_mfma_f32_16x16x32_bf16 v[64:67], v[96:99], v[128:131], v[64:67]
    ds_read_b128 v[176:179], v14 offset:32768
    v_fma_f32 v224, v224, v26, v28
    v_fma_f32 v225, v225, v27, v29
    v_mfma_f32_16x16x32_bf16 v[68:71], v[96:99], v[132:135], v[68:71]
    ds_read_b128 v[180:183], v14 offset:33792
    v_fma_f32 v226, v226, v26, v28
    v_fma_f32 v227, v227, v27, v29
    v_mfma_f32_16x16x32_bf16 v[72:75], v[100:103], v[128:131], v[72:75]
    ds_read_b128 v[144:147], v10 offset:32768
    v_fma_f32 v228, v228, v26, v28
    v_fma_f32 v229, v229, v27, v29
    v_mfma_f32_16x16x32_bf16 v[76:79], v[100:103], v[132:135], v[76:79]
    ds_read_b128 v[148:151], v10 offset:34816
    v_fma_f32 v230, v230, v26, v28
    v_fma_f32 v231, v231, v27, v29
    v_mfma_f32_16x16x32_bf16 v[80:83], v[104:107], v[128:131], v[80:83]
    ds_read_b128 v[152:155], v10 offset:36864
    v_mul_f32 v224, v224, v32
    v_mul_f32 v225, v225, v33
    v_mfma_f32_16x16x32_bf16 v[84:87], v[104:107], v[132:135], v[84:87]
    ds_read_b128 v[156:159], v10 offset:38912
    v_mul_f32 v226, v226, v34
    v_mul_f32 v227, v227, v35
    v_mfma_f32_16x16x32_bf16 v[88:91], v[108:111], v[128:131], v[88:91]
    ds_read_b128 v[184:187], v14 offset:34816
    v_mul_f32 v228, v228, v36
    v_mul_f32 v229, v229, v37
    v_mfma_f32_16x16x32_bf16 v[92:95], v[108:111], v[132:135], v[92:95]
    ds_read_b128 v[188:191], v14 offset:35840
    v_mul_f32 v230, v230, v38
    v_mul_f32 v231, v231, v39
    v_mfma_f32_16x16x32_bf16 v[64:67], v[112:115], v[136:139], v[64:67]
    ds_read_b128 v[160:163], v11 offset:32768
    v_exp_f32 v224, v224
    v_mfma_f32_16x16x32_bf16 v[68:71], v[112:115], v[140:143], v[68:71]
    ds_read_b128 v[164:167], v11 offset:34816
    v_exp_f32 v225, v225
    v_mfma_f32_16x16x32_bf16 v[72:75], v[116:119], v[136:139], v[72:75]
    ds_read_b128 v[168:171], v11 offset:36864
    v_exp_f32 v226, v226
    v_mfma_f32_16x16x32_bf16 v[76:79], v[116:119], v[140:143], v[76:79]
    ds_read_b128 v[172:175], v11 offset:38912
    v_exp_f32 v227, v227
    v_mfma_f32_16x16x32_bf16 v[80:83], v[120:123], v[136:139], v[80:83]
    v_exp_f32 v228, v228
    v_mfma_f32_16x16x32_bf16 v[84:87], v[120:123], v[140:143], v[84:87]
    v_exp_f32 v229, v229
    v_mfma_f32_16x16x32_bf16 v[88:91], v[124:127], v[136:139], v[88:91]
    v_exp_f32 v230, v230
    v_mfma_f32_16x16x32_bf16 v[92:95], v[124:127], v[140:143], v[92:95]
    v_exp_f32 v231, v231
    s_waitcnt lgkmcnt(0)
    s_barrier
    v_mfma_f32_16x16x32_bf16 v[64:67], v[144:147], v[176:179], v[64:67]
    ds_read_b128 v[128:131], v14 offset:49152
    v_add_f32 v224, v224, v30
    v_add_f32 v225, v225, v31
    v_mfma_f32_16x16x32_bf16 v[68:71], v[144:147], v[180:183], v[68:71]
    ds_read_b128 v[132:135], v14 offset:50176
    v_add_f32 v226, v226, v30
    v_add_f32 v227, v227, v31
    v_mfma_f32_16x16x32_bf16 v[72:75], v[148:151], v[176:179], v[72:75]
    ds_read_b128 v[96:99], v10 offset:0
    v_add_f32 v228, v228, v30
    v_add_f32 v229, v229, v31
    v_mfma_f32_16x16x32_bf16 v[76:79], v[148:151], v[180:183], v[76:79]
    ds_read_b128 v[100:103], v10 offset:2048
    v_add_f32 v230, v230, v30
    v_add_f32 v231, v231, v31
    v_mfma_f32_16x16x32_bf16 v[80:83], v[152:155], v[176:179], v[80:83]
    ds_read_b128 v[104:107], v10 offset:4096
    v_rcp_f32 v224, v224
    v_mfma_f32_16x16x32_bf16 v[84:87], v[152:155], v[180:183], v[84:87]
    ds_read_b128 v[108:111], v10 offset:6144
    v_rcp_f32 v225, v225
    v_mfma_f32_16x16x32_bf16 v[88:91], v[156:159], v[176:179], v[88:91]
    ds_read_b128 v[136:139], v14 offset:51200
    v_rcp_f32 v226, v226
    v_mfma_f32_16x16x32_bf16 v[92:95], v[156:159], v[180:183], v[92:95]
    ds_read_b128 v[140:143], v14 offset:52224
    v_rcp_f32 v227, v227
    v_mfma_f32_16x16x32_bf16 v[64:67], v[160:163], v[184:187], v[64:67]
    ds_read_b128 v[112:115], v11 offset:0
    v_rcp_f32 v228, v228
    v_mfma_f32_16x16x32_bf16 v[68:71], v[160:163], v[188:191], v[68:71]
    ds_read_b128 v[116:119], v11 offset:2048
    v_rcp_f32 v229, v229
    v_mfma_f32_16x16x32_bf16 v[72:75], v[164:167], v[184:187], v[72:75]
    ds_read_b128 v[120:123], v11 offset:4096
    v_rcp_f32 v230, v230
    v_mfma_f32_16x16x32_bf16 v[76:79], v[164:167], v[188:191], v[76:79]
    ds_read_b128 v[124:127], v11 offset:6144
    v_rcp_f32 v231, v231
    v_mfma_f32_16x16x32_bf16 v[80:83], v[168:171], v[184:187], v[80:83]
    v_mul_f32 v32, v32, v224
    v_mul_f32 v33, v33, v225
    v_mfma_f32_16x16x32_bf16 v[84:87], v[168:171], v[188:191], v[84:87]
    v_mul_f32 v34, v34, v226
    v_mul_f32 v35, v35, v227
    v_mfma_f32_16x16x32_bf16 v[88:91], v[172:175], v[184:187], v[88:91]
    v_mul_f32 v36, v36, v228
    v_mul_f32 v37, v37, v229
    v_mfma_f32_16x16x32_bf16 v[92:95], v[172:175], v[188:191], v[92:95]
    v_mul_f32 v38, v38, v230
    v_mul_f32 v39, v39, v231
    s_waitcnt lgkmcnt(0)
    s_barrier
    v_mfma_f32_16x16x32_bf16 v[64:67], v[96:99], v[128:131], v[64:67]
    ds_read_b128 v[176:179], v15 offset:0
    v_cvt_pk_bf16_f32 v240, v32, v36
    v_cvt_pk_bf16_f32 v241, v33, v37
    v_mfma_f32_16x16x32_bf16 v[68:71], v[96:99], v[132:135], v[68:71]
    ds_read_b128 v[180:183], v15 offset:1024
    v_cvt_pk_bf16_f32 v242, v34, v38
    v_cvt_pk_bf16_f32 v243, v35, v39
    v_mfma_f32_16x16x32_bf16 v[72:75], v[100:103], v[128:131], v[72:75]
    ds_read_b128 v[144:147], v10 offset:8192
    global_store_dword v12, v240, s[24:25] offset:0
    global_store_dword v12, v241, s[24:25] offset:3584
    v_mfma_f32_16x16x32_bf16 v[76:79], v[100:103], v[132:135], v[76:79]
    ds_read_b128 v[148:151], v10 offset:10240
    global_store_dword v13, v242, s[24:25] offset:0
    global_store_dword v13, v243, s[24:25] offset:3584
    v_mfma_f32_16x16x32_bf16 v[80:83], v[104:107], v[128:131], v[80:83]
    ds_read_b128 v[152:155], v10 offset:12288
    v_add_u32 v12, 57344, v12
    v_add_u32 v13, 57344, v13
    v_mfma_f32_16x16x32_bf16 v[84:87], v[104:107], v[132:135], v[84:87]
    ds_read_b128 v[156:159], v10 offset:14336
    v_fma_f32 v40, v200, v20, v40
    v_fma_f32 v41, v201, v21, v41
    v_mfma_f32_16x16x32_bf16 v[88:91], v[108:111], v[128:131], v[88:91]
    ds_read_b128 v[184:187], v15 offset:2048
    v_fma_f32 v42, v202, v20, v42
    v_fma_f32 v43, v203, v21, v43
    v_mfma_f32_16x16x32_bf16 v[92:95], v[108:111], v[132:135], v[92:95]
    ds_read_b128 v[188:191], v15 offset:3072
    v_fma_f32 v44, v200, v22, v44
    v_fma_f32 v45, v201, v23, v45
    v_mfma_f32_16x16x32_bf16 v[64:67], v[112:115], v[136:139], v[64:67]
    ds_read_b128 v[160:163], v11 offset:8192
    v_fma_f32 v46, v202, v22, v46
    v_fma_f32 v47, v203, v23, v47
    v_mfma_f32_16x16x32_bf16 v[68:71], v[112:115], v[140:143], v[68:71]
    ds_read_b128 v[164:167], v11 offset:10240
    v_mul_f32 v40, v40, v204
    v_mul_f32 v41, v41, v205
    v_mfma_f32_16x16x32_bf16 v[72:75], v[116:119], v[136:139], v[72:75]
    ds_read_b128 v[168:171], v11 offset:12288
    v_mul_f32 v42, v42, v206
    v_mul_f32 v43, v43, v207
    v_mfma_f32_16x16x32_bf16 v[76:79], v[116:119], v[140:143], v[76:79]
    ds_read_b128 v[172:175], v11 offset:14336
    v_mul_f32 v44, v44, v204
    v_mul_f32 v45, v45, v205
    v_mfma_f32_16x16x32_bf16 v[80:83], v[120:123], v[136:139], v[80:83]
    v_mul_f32 v46, v46, v206
    v_mul_f32 v47, v47, v207
    v_mfma_f32_16x16x32_bf16 v[84:87], v[120:123], v[140:143], v[84:87]
    v_mul_f32 v232, v40, v40
    v_mul_f32 v233, v41, v41
    v_mfma_f32_16x16x32_bf16 v[88:91], v[124:127], v[136:139], v[88:91]
    v_mul_f32 v234, v42, v42
    v_mul_f32 v235, v43, v43
    v_mfma_f32_16x16x32_bf16 v[92:95], v[124:127], v[140:143], v[92:95]
    v_mul_f32 v236, v44, v44
    v_mul_f32 v237, v45, v45
    s_waitcnt lgkmcnt(0)
    s_barrier
    v_mfma_f32_16x16x32_bf16 v[64:67], v[144:147], v[176:179], v[64:67]
    ds_read_b128 v[128:131], v15 offset:16384
    v_mul_f32 v238, v46, v46
    v_mul_f32 v239, v47, v47
    v_mfma_f32_16x16x32_bf16 v[68:71], v[144:147], v[180:183], v[68:71]
    ds_read_b128 v[132:135], v15 offset:17408
    v_fma_f32 v232, v232, v26, v28
    v_fma_f32 v233, v233, v27, v29
    v_mfma_f32_16x16x32_bf16 v[72:75], v[148:151], v[176:179], v[72:75]
    ds_read_b128 v[96:99], v10 offset:16384
    v_fma_f32 v234, v234, v26, v28
    v_fma_f32 v235, v235, v27, v29
    v_mfma_f32_16x16x32_bf16 v[76:79], v[148:151], v[180:183], v[76:79]
    ds_read_b128 v[100:103], v10 offset:18432
    v_fma_f32 v236, v236, v26, v28
    v_fma_f32 v237, v237, v27, v29
    v_mfma_f32_16x16x32_bf16 v[80:83], v[152:155], v[176:179], v[80:83]
    ds_read_b128 v[104:107], v10 offset:20480
    v_fma_f32 v238, v238, v26, v28
    v_fma_f32 v239, v239, v27, v29
    v_mfma_f32_16x16x32_bf16 v[84:87], v[152:155], v[180:183], v[84:87]
    ds_read_b128 v[108:111], v10 offset:22528
    v_mul_f32 v232, v232, v40
    v_mul_f32 v233, v233, v41
    v_mfma_f32_16x16x32_bf16 v[88:91], v[156:159], v[176:179], v[88:91]
    ds_read_b128 v[136:139], v15 offset:18432
    v_mul_f32 v234, v234, v42
    v_mul_f32 v235, v235, v43
    v_mfma_f32_16x16x32_bf16 v[92:95], v[156:159], v[180:183], v[92:95]
    ds_read_b128 v[140:143], v15 offset:19456
    v_mul_f32 v236, v236, v44
    v_mul_f32 v237, v237, v45
    v_mfma_f32_16x16x32_bf16 v[64:67], v[160:163], v[184:187], v[64:67]
    ds_read_b128 v[112:115], v11 offset:16384
    v_mul_f32 v238, v238, v46
    v_mul_f32 v239, v239, v47
    v_mfma_f32_16x16x32_bf16 v[68:71], v[160:163], v[188:191], v[68:71]
    ds_read_b128 v[116:119], v11 offset:18432
    v_exp_f32 v232, v232
    v_mfma_f32_16x16x32_bf16 v[72:75], v[164:167], v[184:187], v[72:75]
    ds_read_b128 v[120:123], v11 offset:20480
    v_exp_f32 v233, v233
    v_mfma_f32_16x16x32_bf16 v[76:79], v[164:167], v[188:191], v[76:79]
    ds_read_b128 v[124:127], v11 offset:22528
    v_exp_f32 v234, v234
    v_mfma_f32_16x16x32_bf16 v[80:83], v[168:171], v[184:187], v[80:83]
    v_exp_f32 v235, v235
    v_mfma_f32_16x16x32_bf16 v[84:87], v[168:171], v[188:191], v[84:87]
    v_exp_f32 v236, v236
    v_mfma_f32_16x16x32_bf16 v[88:91], v[172:175], v[184:187], v[88:91]
    v_exp_f32 v237, v237
    v_mfma_f32_16x16x32_bf16 v[92:95], v[172:175], v[188:191], v[92:95]
    v_exp_f32 v238, v238
    s_waitcnt lgkmcnt(0)
    s_barrier
    v_mfma_f32_16x16x32_bf16 v[64:67], v[96:99], v[128:131], v[64:67]
    ds_read_b128 v[176:179], v15 offset:32768
    v_exp_f32 v239, v239
    v_mfma_f32_16x16x32_bf16 v[68:71], v[96:99], v[132:135], v[68:71]
    ds_read_b128 v[180:183], v15 offset:33792
    v_add_f32 v232, v232, v30
    v_add_f32 v233, v233, v31
    v_mfma_f32_16x16x32_bf16 v[72:75], v[100:103], v[128:131], v[72:75]
    ds_read_b128 v[144:147], v10 offset:24576
    v_add_f32 v234, v234, v30
    v_add_f32 v235, v235, v31
    v_mfma_f32_16x16x32_bf16 v[76:79], v[100:103], v[132:135], v[76:79]
    ds_read_b128 v[148:151], v10 offset:26624
    v_add_f32 v236, v236, v30
    v_add_f32 v237, v237, v31
    v_mfma_f32_16x16x32_bf16 v[80:83], v[104:107], v[128:131], v[80:83]
    ds_read_b128 v[152:155], v10 offset:28672
    v_add_f32 v238, v238, v30
    v_add_f32 v239, v239, v31
    v_mfma_f32_16x16x32_bf16 v[84:87], v[104:107], v[132:135], v[84:87]
    ds_read_b128 v[156:159], v10 offset:30720
    v_rcp_f32 v232, v232
    v_mfma_f32_16x16x32_bf16 v[88:91], v[108:111], v[128:131], v[88:91]
    ds_read_b128 v[184:187], v15 offset:34816
    v_rcp_f32 v233, v233
    v_mfma_f32_16x16x32_bf16 v[92:95], v[108:111], v[132:135], v[92:95]
    ds_read_b128 v[188:191], v15 offset:35840
    v_rcp_f32 v234, v234
    v_mfma_f32_16x16x32_bf16 v[64:67], v[112:115], v[136:139], v[64:67]
    ds_read_b128 v[160:163], v11 offset:24576
    v_rcp_f32 v235, v235
    v_mfma_f32_16x16x32_bf16 v[68:71], v[112:115], v[140:143], v[68:71]
    ds_read_b128 v[164:167], v11 offset:26624
    v_rcp_f32 v236, v236
    v_mfma_f32_16x16x32_bf16 v[72:75], v[116:119], v[136:139], v[72:75]
    ds_read_b128 v[168:171], v11 offset:28672
    v_rcp_f32 v237, v237
    v_mfma_f32_16x16x32_bf16 v[76:79], v[116:119], v[140:143], v[76:79]
    ds_read_b128 v[172:175], v11 offset:30720
    v_rcp_f32 v238, v238
    v_mfma_f32_16x16x32_bf16 v[80:83], v[120:123], v[136:139], v[80:83]
    v_rcp_f32 v239, v239
    v_mfma_f32_16x16x32_bf16 v[84:87], v[120:123], v[140:143], v[84:87]
    v_mul_f32 v40, v40, v232
    v_mul_f32 v41, v41, v233
    v_mfma_f32_16x16x32_bf16 v[88:91], v[124:127], v[136:139], v[88:91]
    v_mul_f32 v42, v42, v234
    v_mul_f32 v43, v43, v235
    v_mfma_f32_16x16x32_bf16 v[92:95], v[124:127], v[140:143], v[92:95]
    v_mul_f32 v44, v44, v236
    v_mul_f32 v45, v45, v237
    s_waitcnt lgkmcnt(0)
    v_mfma_f32_16x16x32_bf16 v[64:67], v[144:147], v[176:179], v[64:67]
    v_mul_f32 v46, v46, v238
    v_mul_f32 v47, v47, v239
    v_mfma_f32_16x16x32_bf16 v[68:71], v[144:147], v[180:183], v[68:71]
    v_cvt_pk_bf16_f32 v244, v40, v44
    v_cvt_pk_bf16_f32 v245, v41, v45
    v_mfma_f32_16x16x32_bf16 v[72:75], v[148:151], v[176:179], v[72:75]
    v_cvt_pk_bf16_f32 v246, v42, v46
    v_cvt_pk_bf16_f32 v247, v43, v47
    v_mfma_f32_16x16x32_bf16 v[76:79], v[148:151], v[180:183], v[76:79]
    global_store_dword v12, v244, s[24:25] offset:0
    global_store_dword v12, v245, s[24:25] offset:3584
    v_mfma_f32_16x16x32_bf16 v[80:83], v[152:155], v[176:179], v[80:83]
    global_store_dword v13, v246, s[24:25] offset:0
    global_store_dword v13, v247, s[24:25] offset:3584
    v_mfma_f32_16x16x32_bf16 v[84:87], v[152:155], v[180:183], v[84:87]
    v_add_u32 v12, 57344, v12
    v_add_u32 v13, 57344, v13
    v_mfma_f32_16x16x32_bf16 v[88:91], v[156:159], v[176:179], v[88:91]
    v_fma_f32 v48, v208, v20, v48
    v_fma_f32 v49, v209, v21, v49
    v_mfma_f32_16x16x32_bf16 v[92:95], v[156:159], v[180:183], v[92:95]
    v_fma_f32 v50, v210, v20, v50
    v_fma_f32 v51, v211, v21, v51
    v_mfma_f32_16x16x32_bf16 v[64:67], v[160:163], v[184:187], v[64:67]
    v_fma_f32 v52, v208, v22, v52
    v_fma_f32 v53, v209, v23, v53
    v_mfma_f32_16x16x32_bf16 v[68:71], v[160:163], v[188:191], v[68:71]
    v_fma_f32 v54, v210, v22, v54
    v_fma_f32 v55, v211, v23, v55
    v_mfma_f32_16x16x32_bf16 v[72:75], v[164:167], v[184:187], v[72:75]
    v_mul_f32 v48, v48, v212
    v_mul_f32 v49, v49, v213
    v_mfma_f32_16x16x32_bf16 v[76:79], v[164:167], v[188:191], v[76:79]
    v_mul_f32 v50, v50, v214
    v_mul_f32 v51, v51, v215
    v_mfma_f32_16x16x32_bf16 v[80:83], v[168:171], v[184:187], v[80:83]
    v_mul_f32 v52, v52, v212
    v_mul_f32 v53, v53, v213
    v_mfma_f32_16x16x32_bf16 v[84:87], v[168:171], v[188:191], v[84:87]
    v_mul_f32 v54, v54, v214
    v_mul_f32 v55, v55, v215
    v_mfma_f32_16x16x32_bf16 v[88:91], v[172:175], v[184:187], v[88:91]
    v_mul_f32 v224, v48, v48
    v_mul_f32 v225, v49, v49
    v_mfma_f32_16x16x32_bf16 v[92:95], v[172:175], v[188:191], v[92:95]
    v_mul_f32 v226, v50, v50
    v_mul_f32 v227, v51, v51
    v_mul_f32 v228, v52, v52
    v_mul_f32 v229, v53, v53
    v_mul_f32 v230, v54, v54
    v_mul_f32 v231, v55, v55
    v_fma_f32 v224, v224, v26, v28
    v_fma_f32 v225, v225, v27, v29
    v_fma_f32 v226, v226, v26, v28
    v_fma_f32 v227, v227, v27, v29
    v_fma_f32 v228, v228, v26, v28
    v_fma_f32 v229, v229, v27, v29
    v_fma_f32 v230, v230, v26, v28
    v_fma_f32 v231, v231, v27, v29
    v_mul_f32 v224, v224, v48
    v_mul_f32 v225, v225, v49
    v_mul_f32 v226, v226, v50
    v_mul_f32 v227, v227, v51
    v_mul_f32 v228, v228, v52
    v_mul_f32 v229, v229, v53
    v_mul_f32 v230, v230, v54
    v_mul_f32 v231, v231, v55
    v_exp_f32 v224, v224
    v_exp_f32 v225, v225
    v_exp_f32 v226, v226
    v_exp_f32 v227, v227
    v_exp_f32 v228, v228
    v_exp_f32 v229, v229
    v_exp_f32 v230, v230
    v_exp_f32 v231, v231
    v_add_f32 v224, v224, v30
    v_add_f32 v225, v225, v31
    v_add_f32 v226, v226, v30
    v_add_f32 v227, v227, v31
    v_add_f32 v228, v228, v30
    v_add_f32 v229, v229, v31
    v_add_f32 v230, v230, v30
    v_add_f32 v231, v231, v31
    v_rcp_f32 v224, v224
    v_rcp_f32 v225, v225
    v_rcp_f32 v226, v226
    v_rcp_f32 v227, v227
    v_rcp_f32 v228, v228
    v_rcp_f32 v229, v229
    v_rcp_f32 v230, v230
    v_rcp_f32 v231, v231
    v_mul_f32 v48, v48, v224
    v_mul_f32 v49, v49, v225
    v_mul_f32 v50, v50, v226
    v_mul_f32 v51, v51, v227
    v_mul_f32 v52, v52, v228
    v_mul_f32 v53, v53, v229
    v_mul_f32 v54, v54, v230
    v_mul_f32 v55, v55, v231
    v_cvt_pk_bf16_f32 v240, v48, v52
    v_cvt_pk_bf16_f32 v241, v49, v53
    v_cvt_pk_bf16_f32 v242, v50, v54
    v_cvt_pk_bf16_f32 v243, v51, v55
    global_store_dword v12, v240, s[24:25] offset:0
    global_store_dword v12, v241, s[24:25] offset:3584
    global_store_dword v13, v242, s[24:25] offset:0
    global_store_dword v13, v243, s[24:25] offset:3584
    v_add_u32 v12, 57344, v12
    v_add_u32 v13, 57344, v13
    v_pk_fma_f32 v[56:57], v[216:217], v[20:21], v[56:57]
    v_pk_fma_f32 v[58:59], v[218:219], v[20:21], v[58:59]
    v_pk_fma_f32 v[60:61], v[216:217], v[22:23], v[60:61]
    v_pk_fma_f32 v[62:63], v[218:219], v[22:23], v[62:63]
    v_pk_mul_f32 v[56:57], v[56:57], v[220:221]
    v_pk_mul_f32 v[58:59], v[58:59], v[222:223]
    v_pk_mul_f32 v[60:61], v[60:61], v[220:221]
    v_pk_mul_f32 v[62:63], v[62:63], v[222:223]
    v_pk_mul_f32 v[232:233], v[56:57], v[56:57]
    v_pk_mul_f32 v[234:235], v[58:59], v[58:59]
    v_pk_mul_f32 v[236:237], v[60:61], v[60:61]
    v_pk_mul_f32 v[238:239], v[62:63], v[62:63]
    v_pk_fma_f32 v[232:233], v[232:233], v[26:27], v[28:29]
    v_pk_fma_f32 v[234:235], v[234:235], v[26:27], v[28:29]
    v_pk_fma_f32 v[236:237], v[236:237], v[26:27], v[28:29]
    v_pk_fma_f32 v[238:239], v[238:239], v[26:27], v[28:29]
    v_pk_mul_f32 v[232:233], v[232:233], v[56:57]
    v_pk_mul_f32 v[234:235], v[234:235], v[58:59]
    v_pk_mul_f32 v[236:237], v[236:237], v[60:61]
    v_pk_mul_f32 v[238:239], v[238:239], v[62:63]
    v_exp_f32 v232, v232
    v_exp_f32 v233, v233
    v_exp_f32 v234, v234
    v_exp_f32 v235, v235
    v_exp_f32 v236, v236
    v_exp_f32 v237, v237
    v_exp_f32 v238, v238
    v_exp_f32 v239, v239
    v_pk_add_f32 v[232:233], v[232:233], v[30:31]
    v_pk_add_f32 v[234:235], v[234:235], v[30:31]
    v_pk_add_f32 v[236:237], v[236:237], v[30:31]
    v_pk_add_f32 v[238:239], v[238:239], v[30:31]
    v_rcp_f32 v232, v232
    v_rcp_f32 v233, v233
    v_rcp_f32 v234, v234
    v_rcp_f32 v235, v235
    v_rcp_f32 v236, v236
    v_rcp_f32 v237, v237
    v_rcp_f32 v238, v238
    v_rcp_f32 v239, v239
    v_pk_mul_f32 v[56:57], v[56:57], v[232:233]
    v_pk_mul_f32 v[58:59], v[58:59], v[234:235]
    v_pk_mul_f32 v[60:61], v[60:61], v[236:237]
    v_pk_mul_f32 v[62:63], v[62:63], v[238:239]
    v_cvt_pk_bf16_f32 v244, v56, v60
    v_cvt_pk_bf16_f32 v245, v57, v61
    v_cvt_pk_bf16_f32 v246, v58, v62
    v_cvt_pk_bf16_f32 v247, v59, v63
    global_store_dword v12, v244, s[24:25] offset:0
    global_store_dword v12, v245, s[24:25] offset:3584
    global_store_dword v13, v246, s[24:25] offset:0
    global_store_dword v13, v247, s[24:25] offset:3584
    v_add_u32 v12, 57344, v12
    v_add_u32 v13, 57344, v13
    ds_read_b128 v[192:195], v9 offset:256
    ds_read_b128 v[196:199], v9 offset:768
    ds_read_b128 v[200:203], v9 offset:320
    ds_read_b128 v[204:207], v9 offset:832
    ds_read_b128 v[208:211], v9 offset:384
    ds_read_b128 v[212:215], v9 offset:896
    ds_read_b128 v[216:219], v9 offset:448
    ds_read_b128 v[220:223], v9 offset:960
    s_waitcnt lgkmcnt(0)
    v_pk_fma_f32 v[64:65], v[192:193], v[20:21], v[64:65]
    v_pk_fma_f32 v[66:67], v[194:195], v[20:21], v[66:67]
    v_pk_fma_f32 v[68:69], v[192:193], v[22:23], v[68:69]
    v_pk_fma_f32 v[70:71], v[194:195], v[22:23], v[70:71]
    v_pk_mul_f32 v[64:65], v[64:65], v[196:197]
    v_pk_mul_f32 v[66:67], v[66:67], v[198:199]
    v_pk_mul_f32 v[68:69], v[68:69], v[196:197]
    v_pk_mul_f32 v[70:71], v[70:71], v[198:199]
    v_pk_mul_f32 v[224:225], v[64:65], v[64:65]
    v_pk_mul_f32 v[226:227], v[66:67], v[66:67]
    v_pk_mul_f32 v[228:229], v[68:69], v[68:69]
    v_pk_mul_f32 v[230:231], v[70:71], v[70:71]
    v_pk_fma_f32 v[224:225], v[224:225], v[26:27], v[28:29]
    v_pk_fma_f32 v[226:227], v[226:227], v[26:27], v[28:29]
    v_pk_fma_f32 v[228:229], v[228:229], v[26:27], v[28:29]
    v_pk_fma_f32 v[230:231], v[230:231], v[26:27], v[28:29]
    v_pk_mul_f32 v[224:225], v[224:225], v[64:65]
    v_pk_mul_f32 v[226:227], v[226:227], v[66:67]
    v_pk_mul_f32 v[228:229], v[228:229], v[68:69]
    v_pk_mul_f32 v[230:231], v[230:231], v[70:71]
    v_exp_f32 v224, v224
    v_exp_f32 v225, v225
    v_exp_f32 v226, v226
    v_exp_f32 v227, v227
    v_exp_f32 v228, v228
    v_exp_f32 v229, v229
    v_exp_f32 v230, v230
    v_exp_f32 v231, v231
    v_pk_add_f32 v[224:225], v[224:225], v[30:31]
    v_pk_add_f32 v[226:227], v[226:227], v[30:31]
    v_pk_add_f32 v[228:229], v[228:229], v[30:31]
    v_pk_add_f32 v[230:231], v[230:231], v[30:31]
    v_rcp_f32 v224, v224
    v_rcp_f32 v225, v225
    v_rcp_f32 v226, v226
    v_rcp_f32 v227, v227
    v_rcp_f32 v228, v228
    v_rcp_f32 v229, v229
    v_rcp_f32 v230, v230
    v_rcp_f32 v231, v231
    v_pk_mul_f32 v[64:65], v[64:65], v[224:225]
    v_pk_mul_f32 v[66:67], v[66:67], v[226:227]
    v_pk_mul_f32 v[68:69], v[68:69], v[228:229]
    v_pk_mul_f32 v[70:71], v[70:71], v[230:231]
    v_cvt_pk_bf16_f32 v240, v64, v68
    v_cvt_pk_bf16_f32 v241, v65, v69
    v_cvt_pk_bf16_f32 v242, v66, v70
    v_cvt_pk_bf16_f32 v243, v67, v71
    global_store_dword v12, v240, s[24:25] offset:0
    global_store_dword v12, v241, s[24:25] offset:3584
    global_store_dword v13, v242, s[24:25] offset:0
    global_store_dword v13, v243, s[24:25] offset:3584
    v_add_u32 v12, 57344, v12
    v_add_u32 v13, 57344, v13
    v_pk_fma_f32 v[72:73], v[200:201], v[20:21], v[72:73]
    v_pk_fma_f32 v[74:75], v[202:203], v[20:21], v[74:75]
    v_pk_fma_f32 v[76:77], v[200:201], v[22:23], v[76:77]
    v_pk_fma_f32 v[78:79], v[202:203], v[22:23], v[78:79]
    v_pk_mul_f32 v[72:73], v[72:73], v[204:205]
    v_pk_mul_f32 v[74:75], v[74:75], v[206:207]
    v_pk_mul_f32 v[76:77], v[76:77], v[204:205]
    v_pk_mul_f32 v[78:79], v[78:79], v[206:207]
    v_pk_mul_f32 v[232:233], v[72:73], v[72:73]
    v_pk_mul_f32 v[234:235], v[74:75], v[74:75]
    v_pk_mul_f32 v[236:237], v[76:77], v[76:77]
    v_pk_mul_f32 v[238:239], v[78:79], v[78:79]
    v_pk_fma_f32 v[232:233], v[232:233], v[26:27], v[28:29]
    v_pk_fma_f32 v[234:235], v[234:235], v[26:27], v[28:29]
    v_pk_fma_f32 v[236:237], v[236:237], v[26:27], v[28:29]
    v_pk_fma_f32 v[238:239], v[238:239], v[26:27], v[28:29]
    v_pk_mul_f32 v[232:233], v[232:233], v[72:73]
    v_pk_mul_f32 v[234:235], v[234:235], v[74:75]
    v_pk_mul_f32 v[236:237], v[236:237], v[76:77]
    v_pk_mul_f32 v[238:239], v[238:239], v[78:79]
    v_exp_f32 v232, v232
    v_exp_f32 v233, v233
    v_exp_f32 v234, v234
    v_exp_f32 v235, v235
    v_exp_f32 v236, v236
    v_exp_f32 v237, v237
    v_exp_f32 v238, v238
    v_exp_f32 v239, v239
    v_pk_add_f32 v[232:233], v[232:233], v[30:31]
    v_pk_add_f32 v[234:235], v[234:235], v[30:31]
    v_pk_add_f32 v[236:237], v[236:237], v[30:31]
    v_pk_add_f32 v[238:239], v[238:239], v[30:31]
    v_rcp_f32 v232, v232
    v_rcp_f32 v233, v233
    v_rcp_f32 v234, v234
    v_rcp_f32 v235, v235
    v_rcp_f32 v236, v236
    v_rcp_f32 v237, v237
    v_rcp_f32 v238, v238
    v_rcp_f32 v239, v239
    v_pk_mul_f32 v[72:73], v[72:73], v[232:233]
    v_pk_mul_f32 v[74:75], v[74:75], v[234:235]
    v_pk_mul_f32 v[76:77], v[76:77], v[236:237]
    v_pk_mul_f32 v[78:79], v[78:79], v[238:239]
    v_cvt_pk_bf16_f32 v244, v72, v76
    v_cvt_pk_bf16_f32 v245, v73, v77
    v_cvt_pk_bf16_f32 v246, v74, v78
    v_cvt_pk_bf16_f32 v247, v75, v79
    global_store_dword v12, v244, s[24:25] offset:0
    global_store_dword v12, v245, s[24:25] offset:3584
    global_store_dword v13, v246, s[24:25] offset:0
    global_store_dword v13, v247, s[24:25] offset:3584
    v_add_u32 v12, 57344, v12
    v_add_u32 v13, 57344, v13
    v_pk_fma_f32 v[80:81], v[208:209], v[20:21], v[80:81]
    v_pk_fma_f32 v[82:83], v[210:211], v[20:21], v[82:83]
    v_pk_fma_f32 v[84:85], v[208:209], v[22:23], v[84:85]
    v_pk_fma_f32 v[86:87], v[210:211], v[22:23], v[86:87]
    v_pk_mul_f32 v[80:81], v[80:81], v[212:213]
    v_pk_mul_f32 v[82:83], v[82:83], v[214:215]
    v_pk_mul_f32 v[84:85], v[84:85], v[212:213]
    v_pk_mul_f32 v[86:87], v[86:87], v[214:215]
    v_pk_mul_f32 v[224:225], v[80:81], v[80:81]
    v_pk_mul_f32 v[226:227], v[82:83], v[82:83]
    v_pk_mul_f32 v[228:229], v[84:85], v[84:85]
    v_pk_mul_f32 v[230:231], v[86:87], v[86:87]
    v_pk_fma_f32 v[224:225], v[224:225], v[26:27], v[28:29]
    v_pk_fma_f32 v[226:227], v[226:227], v[26:27], v[28:29]
    v_pk_fma_f32 v[228:229], v[228:229], v[26:27], v[28:29]
    v_pk_fma_f32 v[230:231], v[230:231], v[26:27], v[28:29]
    v_pk_mul_f32 v[224:225], v[224:225], v[80:81]
    v_pk_mul_f32 v[226:227], v[226:227], v[82:83]
    v_pk_mul_f32 v[228:229], v[228:229], v[84:85]
    v_pk_mul_f32 v[230:231], v[230:231], v[86:87]
    v_exp_f32 v224, v224
    v_exp_f32 v225, v225
    v_exp_f32 v226, v226
    v_exp_f32 v227, v227
    v_exp_f32 v228, v228
    v_exp_f32 v229, v229
    v_exp_f32 v230, v230
    v_exp_f32 v231, v231
    v_pk_add_f32 v[224:225], v[224:225], v[30:31]
    v_pk_add_f32 v[226:227], v[226:227], v[30:31]
    v_pk_add_f32 v[228:229], v[228:229], v[30:31]
    v_pk_add_f32 v[230:231], v[230:231], v[30:31]
    v_rcp_f32 v224, v224
    v_rcp_f32 v225, v225
    v_rcp_f32 v226, v226
    v_rcp_f32 v227, v227
    v_rcp_f32 v228, v228
    v_rcp_f32 v229, v229
    v_rcp_f32 v230, v230
    v_rcp_f32 v231, v231
    v_pk_mul_f32 v[80:81], v[80:81], v[224:225]
    v_pk_mul_f32 v[82:83], v[82:83], v[226:227]
    v_pk_mul_f32 v[84:85], v[84:85], v[228:229]
    v_pk_mul_f32 v[86:87], v[86:87], v[230:231]
    v_cvt_pk_bf16_f32 v240, v80, v84
    v_cvt_pk_bf16_f32 v241, v81, v85
    v_cvt_pk_bf16_f32 v242, v82, v86
    v_cvt_pk_bf16_f32 v243, v83, v87
    global_store_dword v12, v240, s[24:25] offset:0
    global_store_dword v12, v241, s[24:25] offset:3584
    global_store_dword v13, v242, s[24:25] offset:0
    global_store_dword v13, v243, s[24:25] offset:3584
    v_add_u32 v12, 57344, v12
    v_add_u32 v13, 57344, v13
    v_pk_fma_f32 v[88:89], v[216:217], v[20:21], v[88:89]
    v_pk_fma_f32 v[90:91], v[218:219], v[20:21], v[90:91]
    v_pk_fma_f32 v[92:93], v[216:217], v[22:23], v[92:93]
    v_pk_fma_f32 v[94:95], v[218:219], v[22:23], v[94:95]
    v_pk_mul_f32 v[88:89], v[88:89], v[220:221]
    v_pk_mul_f32 v[90:91], v[90:91], v[222:223]
    v_pk_mul_f32 v[92:93], v[92:93], v[220:221]
    v_pk_mul_f32 v[94:95], v[94:95], v[222:223]
    v_pk_mul_f32 v[232:233], v[88:89], v[88:89]
    v_pk_mul_f32 v[234:235], v[90:91], v[90:91]
    v_pk_mul_f32 v[236:237], v[92:93], v[92:93]
    v_pk_mul_f32 v[238:239], v[94:95], v[94:95]
    v_pk_fma_f32 v[232:233], v[232:233], v[26:27], v[28:29]
    v_pk_fma_f32 v[234:235], v[234:235], v[26:27], v[28:29]
    v_pk_fma_f32 v[236:237], v[236:237], v[26:27], v[28:29]
    v_pk_fma_f32 v[238:239], v[238:239], v[26:27], v[28:29]
    v_pk_mul_f32 v[232:233], v[232:233], v[88:89]
    v_pk_mul_f32 v[234:235], v[234:235], v[90:91]
    v_pk_mul_f32 v[236:237], v[236:237], v[92:93]
    v_pk_mul_f32 v[238:239], v[238:239], v[94:95]
    v_exp_f32 v232, v232
    v_exp_f32 v233, v233
    v_exp_f32 v234, v234
    v_exp_f32 v235, v235
    v_exp_f32 v236, v236
    v_exp_f32 v237, v237
    v_exp_f32 v238, v238
    v_exp_f32 v239, v239
    v_pk_add_f32 v[232:233], v[232:233], v[30:31]
    v_pk_add_f32 v[234:235], v[234:235], v[30:31]
    v_pk_add_f32 v[236:237], v[236:237], v[30:31]
    v_pk_add_f32 v[238:239], v[238:239], v[30:31]
    v_rcp_f32 v232, v232
    v_rcp_f32 v233, v233
    v_rcp_f32 v234, v234
    v_rcp_f32 v235, v235
    v_rcp_f32 v236, v236
    v_rcp_f32 v237, v237
    v_rcp_f32 v238, v238
    v_rcp_f32 v239, v239
    v_pk_mul_f32 v[88:89], v[88:89], v[232:233]
    v_pk_mul_f32 v[90:91], v[90:91], v[234:235]
    v_pk_mul_f32 v[92:93], v[92:93], v[236:237]
    v_pk_mul_f32 v[94:95], v[94:95], v[238:239]
    v_cvt_pk_bf16_f32 v244, v88, v92
    v_cvt_pk_bf16_f32 v245, v89, v93
    v_cvt_pk_bf16_f32 v246, v90, v94
    v_cvt_pk_bf16_f32 v247, v91, v95
    global_store_dword v12, v244, s[24:25] offset:0
    global_store_dword v12, v245, s[24:25] offset:3584
    global_store_dword v13, v246, s[24:25] offset:0
    global_store_dword v13, v247, s[24:25] offset:3584
K5_END:
    s_endpgm
.globl gemm4_kernel
.p2align 8
.type gemm4_kernel,@function
gemm4_kernel:
    s_cmp_ge_u32 s2, 224
    s_cbranch_scc1 K6_END
    s_load_dwordx2 s[4:5], s[0:1], 128
    s_load_dwordx2 s[8:9], s[0:1], 144
    s_lshr_b32 s10, s2, 3
    s_mul_i32 s11, s10, 37
    s_lshr_b32 s11, s11, 8
    s_mul_i32 s12, s11, 7
    s_sub_u32 s12, s10, s12
    s_and_b32 s10, s2, 7
    s_lshl_b32 s10, s10, 2
    s_add_u32 s3, s10, s11
    s_lshl_b32 s3, s3, 6
    v_lshrrev_b32 v1, 6, v0
    s_nop 0
    v_readfirstlane_b32 s13, v1
    v_and_b32 v2, 15, v0
    v_bfe_u32 v3, v0, 4, 2
    v_and_b32 v4, 63, v0
    s_cmp_lt_u32 s13, 4
    s_cbranch_scc1 K6_COMP
    s_sub_u32 s13, s13, 4
    s_lshl_b32 s14, s11, 1
    s_add_u32 s14, s14, s12
    s_lshl_b32 s14, s14, 1
    s_cmp_ge_u32 s14, 14
    s_cselect_b32 s15, 14, 0
    s_sub_u32 s14, s14, s15
    s_mov_b32 s14, 0
    v_lshrrev_b32 v5, 3, v4
    v_and_b32 v6, 6, v5
    v_xor_b32 v6, v6, v4
    v_and_b32 v6, 7, v6
    s_lshl_b32 s10, s13, 4
    s_add_u32 s10, s10, s3
    v_add_u32 v5, s10, v5
    v_mul_u32_u24 v5, 3584, v5
    v_lshl_add_u32 v5, v6, 4, v5
    v_add_u32 v14, 28672, v5
    s_lshl_b32 s10, s12, 2
    s_add_u32 s10, s10, s13
    s_mul_i32 s11, s10, 57344
    v_lshl_add_u32 v6, v4, 4, s11
    s_lshl_b32 s24, s13, 11
    s_lshl_b32 s25, s13, 12
    s_add_u32 s25, s25, 16384
    s_waitcnt lgkmcnt(0)
    s_add_u32 s16, s8, 29360128
    s_addc_u32 s17, s9, 0
    s_mov_b32 s18, 7340032
    s_mov_b32 s19, 0x00020000
    s_add_u32 s20, s8, 46137344
    s_addc_u32 s21, s9, 0
    s_mov_b32 s22, 1605632
    s_mov_b32 s23, 0x00020000
    s_lshl_b32 s26, s14, 8
    s_lshl_b32 s27, s14, 12
    s_add_u32 m0, s24, 0
    s_nop 0
    buffer_load_dwordx4 v5, s[16:19], s26 offen offset:0 lds
    s_add_u32 m0, s24, 1024
    s_nop 0
    buffer_load_dwordx4 v14, s[16:19], s26 offen offset:0 lds
    s_add_u32 m0, s24, 8064
    s_nop 0
    buffer_load_dwordx4 v5, s[16:19], s26 offen offset:128 lds
    s_add_u32 m0, s24, 9088
    s_nop 0
    buffer_load_dwordx4 v14, s[16:19], s26 offen offset:128 lds
    s_add_u32 m0, s25, 0
    s_nop 0
    buffer_load_dwordx4 v6, s[20:23], s27 offen offset:0 lds
    s_add_u32 m0, s25, 0
    s_nop 0
    buffer_load_dwordx4 v6, s[20:23], s27 offen offset:1024 lds
    s_add_u32 m0, s25, 0
    s_nop 0
    buffer_load_dwordx4 v6, s[20:23], s27 offen offset:2048 lds
    s_add_u32 m0, s25, 0
    s_nop 0
    buffer_load_dwordx4 v6, s[20:23], s27 offen offset:3072 lds
    s_add_u32 s14, s14, 1
    s_cmp_eq_u32 s14, 14
    s_cselect_b32 s14, 0, s14
    s_lshl_b32 s26, s14, 8
    s_lshl_b32 s27, s14, 12
    s_add_u32 m0, s24, 32768
    s_nop 0
    buffer_load_dwordx4 v5, s[16:19], s26 offen offset:0 lds
    s_add_u32 m0, s24, 33792
    s_nop 0
    buffer_load_dwordx4 v14, s[16:19], s26 offen offset:0 lds
    s_add_u32 m0, s24, 40832
    s_nop 0
    buffer_load_dwordx4 v5, s[16:19], s26 offen offset:128 lds
    s_add_u32 m0, s24, 41856
    s_nop 0
    buffer_load_dwordx4 v14, s[16:19], s26 offen offset:128 lds
    s_add_u32 m0, s25, 32768
    s_nop 0
    buffer_load_dwordx4 v6, s[20:23], s27 offen offset:0 lds
    s_add_u32 m0, s25, 32768
    s_nop 0
    buffer_load_dwordx4 v6, s[20:23], s27 offen offset:1024 lds
    s_add_u32 m0, s25, 32768
    s_nop 0
    buffer_load_dwordx4 v6, s[20:23], s27 offen offset:2048 lds
    s_add_u32 m0, s25, 32768
    s_nop 0
    buffer_load_dwordx4 v6, s[20:23], s27 offen offset:3072 lds
    s_add_u32 s14, s14, 1
    s_cmp_eq_u32 s14, 14
    s_cselect_b32 s14, 0, s14
    s_lshl_b32 s26, s14, 8
    s_lshl_b32 s27, s14, 12
    s_add_u32 m0, s24, 65536
    s_nop 0
    buffer_load_dwordx4 v5, s[16:19], s26 offen offset:0 lds
    s_add_u32 m0, s24, 66560
    s_nop 0
    buffer_load_dwordx4 v14, s[16:19], s26 offen offset:0 lds
    s_add_u32 m0, s24, 73600
    s_nop 0
    buffer_load_dwordx4 v5, s[16:19], s26 offen offset:128 lds
    s_add_u32 m0, s24, 74624
    s_nop 0
    buffer_load_dwordx4 v14, s[16:19], s26 offen offset:128 lds
    s_add_u32 m0, s25, 65536
    s_nop 0
    buffer_load_dwordx4 v6, s[20:23], s27 offen offset:0 lds
    s_add_u32 m0, s25, 65536
    s_nop 0
    buffer_load_dwordx4 v6, s[20:23], s27 offen offset:1024 lds
    s_add_u32 m0, s25, 65536
    s_nop 0
    buffer_load_dwordx4 v6, s[20:23], s27 offen offset:2048 lds
    s_add_u32 m0, s25, 65536
    s_nop 0
    buffer_load_dwordx4 v6, s[20:23], s27 offen offset:3072 lds
    s_add_u32 s14, s14, 1
    s_cmp_eq_u32 s14, 14
    s_cselect_b32 s14, 0, s14
    s_lshl_b32 s26, s14, 8
    s_lshl_b32 s27, s14, 12
    s_add_u32 m0, s24, 98304
    s_nop 0
    buffer_load_dwordx4 v5, s[16:19], s26 offen offset:0 lds
    s_add_u32 m0, s24, 99328
    s_nop 0
    buffer_load_dwordx4 v14, s[16:19], s26 offen offset:0 lds
    s_add_u32 m0, s24, 106368
    s_nop 0
    buffer_load_dwordx4 v5, s[16:19], s26 offen offset:128 lds
    s_add_u32 m0, s24, 107392
    s_nop 0
    buffer_load_dwordx4 v14, s[16:19], s26 offen offset:128 lds
    s_add_u32 m0, s25, 98304
    s_nop 0
    buffer_load_dwordx4 v6, s[20:23], s27 offen offset:0 lds
    s_add_u32 m0, s25, 98304
    s_nop 0
    buffer_load_dwordx4 v6, s[20:23], s27 offen offset:1024 lds
    s_add_u32 m0, s25, 98304
    s_nop 0
    buffer_load_dwordx4 v6, s[20:23], s27 offen offset:2048 lds
    s_add_u32 m0, s25, 98304
    s_nop 0
    buffer_load_dwordx4 v6, s[20:23], s27 offen offset:3072 lds
    s_add_u32 s14, s14, 1
    s_cmp_eq_u32 s14, 14
    s_cselect_b32 s14, 0, s14
    s_waitcnt vmcnt(24)
    s_barrier
    s_lshl_b32 s26, s14, 8
    s_lshl_b32 s27, s14, 12
    s_add_u32 m0, s24, 131072
    s_nop 0
    buffer_load_dwordx4 v5, s[16:19], s26 offen offset:0 lds
    s_add_u32 m0, s24, 132096
    s_nop 0
    buffer_load_dwordx4 v14, s[16:19], s26 offen offset:0 lds
    s_add_u32 m0, s24, 139136
    s_nop 0
    buffer_load_dwordx4 v5, s[16:19], s26 offen offset:128 lds
    s_add_u32 m0, s24, 140160
    s_nop 0
    buffer_load_dwordx4 v14, s[16:19], s26 offen offset:128 lds
    s_add_u32 m0, s25, 131072
    s_nop 0
    buffer_load_dwordx4 v6, s[20:23], s27 offen offset:0 lds
    s_add_u32 m0, s25, 131072
    s_nop 0
    buffer_load_dwordx4 v6, s[20:23], s27 offen offset:1024 lds
    s_add_u32 m0, s25, 131072
    s_nop 0
    buffer_load_dwordx4 v6, s[20:23], s27 offen offset:2048 lds
    s_add_u32 m0, s25, 131072
    s_nop 0
    buffer_load_dwordx4 v6, s[20:23], s27 offen offset:3072 lds
    s_add_u32 s14, s14, 1
    s_cmp_eq_u32 s14, 14
    s_cselect_b32 s14, 0, s14
    s_waitcnt vmcnt(24)
    s_barrier
    s_lshl_b32 s26, s14, 8
    s_lshl_b32 s27, s14, 12
    s_add_u32 m0, s24, 0
    s_nop 0
    buffer_load_dwordx4 v5, s[16:19], s26 offen offset:0 lds
    s_add_u32 m0, s24, 1024
    s_nop 0
    buffer_load_dwordx4 v14, s[16:19], s26 offen offset:0 lds
    s_add_u32 m0, s24, 8064
    s_nop 0
    buffer_load_dwordx4 v5, s[16:19], s26 offen offset:128 lds
    s_add_u32 m0, s24, 9088
    s_nop 0
    buffer_load_dwordx4 v14, s[16:19], s26 offen offset:128 lds
    s_add_u32 m0, s25, 0
    s_nop 0
    buffer_load_dwordx4 v6, s[20:23], s27 offen offset:0 lds
    s_add_u32 m0, s25, 0
    s_nop 0
    buffer_load_dwordx4 v6, s[20:23], s27 offen offset:1024 lds
    s_add_u32 m0, s25, 0
    s_nop 0
    buffer_load_dwordx4 v6, s[20:23], s27 offen offset:2048 lds
    s_add_u32 m0, s25, 0
    s_nop 0
    buffer_load_dwordx4 v6, s[20:23], s27 offen offset:3072 lds
    s_add_u32 s14, s14, 1
    s_cmp_eq_u32 s14, 14
    s_cselect_b32 s14, 0, s14
    s_waitcnt vmcnt(24)
    s_barrier
    s_lshl_b32 s26, s14, 8
    s_lshl_b32 s27, s14, 12
    s_add_u32 m0, s24, 32768
    s_nop 0
    buffer_load_dwordx4 v5, s[16:19], s26 offen offset:0 lds
    s_add_u32 m0, s24, 33792
    s_nop 0
    buffer_load_dwordx4 v14, s[16:19], s26 offen offset:0 lds
    s_add_u32 m0, s24, 40832
    s_nop 0
    buffer_load_dwordx4 v5, s[16:19], s26 offen offset:128 lds
    s_add_u32 m0, s24, 41856
    s_nop 0
    buffer_load_dwordx4 v14, s[16:19], s26 offen offset:128 lds
    s_add_u32 m0, s25, 32768
    s_nop 0
    buffer_load_dwordx4 v6, s[20:23], s27 offen offset:0 lds
    s_add_u32 m0, s25, 32768
    s_nop 0
    buffer_load_dwordx4 v6, s[20:23], s27 offen offset:1024 lds
    s_add_u32 m0, s25, 32768
    s_nop 0
    buffer_load_dwordx4 v6, s[20:23], s27 offen offset:2048 lds
    s_add_u32 m0, s25, 32768
    s_nop 0
    buffer_load_dwordx4 v6, s[20:23], s27 offen offset:3072 lds
    s_add_u32 s14, s14, 1
    s_cmp_eq_u32 s14, 14
    s_cselect_b32 s14, 0, s14
    s_waitcnt vmcnt(24)
    s_barrier
    s_lshl_b32 s26, s14, 8
    s_lshl_b32 s27, s14, 12
    s_add_u32 m0, s24, 65536
    s_nop 0
    buffer_load_dwordx4 v5, s[16:19], s26 offen offset:0 lds
    s_add_u32 m0, s24, 66560
    s_nop 0
    buffer_load_dwordx4 v14, s[16:19], s26 offen offset:0 lds
    s_add_u32 m0, s24, 73600
    s_nop 0
    buffer_load_dwordx4 v5, s[16:19], s26 offen offset:128 lds
    s_add_u32 m0, s24, 74624
    s_nop 0
    buffer_load_dwordx4 v14, s[16:19], s26 offen offset:128 lds
    s_add_u32 m0, s25, 65536
    s_nop 0
    buffer_load_dwordx4 v6, s[20:23], s27 offen offset:0 lds
    s_add_u32 m0, s25, 65536
    s_nop 0
    buffer_load_dwordx4 v6, s[20:23], s27 offen offset:1024 lds
    s_add_u32 m0, s25, 65536
    s_nop 0
    buffer_load_dwordx4 v6, s[20:23], s27 offen offset:2048 lds
    s_add_u32 m0, s25, 65536
    s_nop 0
    buffer_load_dwordx4 v6, s[20:23], s27 offen offset:3072 lds
    s_add_u32 s14, s14, 1
    s_cmp_eq_u32 s14, 14
    s_cselect_b32 s14, 0, s14
    s_waitcnt vmcnt(24)
    s_barrier
    s_lshl_b32 s26, s14, 8
    s_lshl_b32 s27, s14, 12
    s_add_u32 m0, s24, 98304
    s_nop 0
    buffer_load_dwordx4 v5, s[16:19], s26 offen offset:0 lds
    s_add_u32 m0, s24, 99328
    s_nop 0
    buffer_load_dwordx4 v14, s[16:19], s26 offen offset:0 lds
    s_add_u32 m0, s24, 106368
    s_nop 0
    buffer_load_dwordx4 v5, s[16:19], s26 offen offset:128 lds
    s_add_u32 m0, s24, 107392
    s_nop 0
    buffer_load_dwordx4 v14, s[16:19], s26 offen offset:128 lds
    s_add_u32 m0, s25, 98304
    s_nop 0
    buffer_load_dwordx4 v6, s[20:23], s27 offen offset:0 lds
    s_add_u32 m0, s25, 98304
    s_nop 0
    buffer_load_dwordx4 v6, s[20:23], s27 offen offset:1024 lds
    s_add_u32 m0, s25, 98304
    s_nop 0
    buffer_load_dwordx4 v6, s[20:23], s27 offen offset:2048 lds
    s_add_u32 m0, s25, 98304
    s_nop 0
    buffer_load_dwordx4 v6, s[20:23], s27 offen offset:3072 lds
    s_add_u32 s14, s14, 1
    s_cmp_eq_u32 s14, 14
    s_cselect_b32 s14, 0, s14
    s_waitcnt vmcnt(24)
    s_barrier
    s_lshl_b32 s26, s14, 8
    s_lshl_b32 s27, s14, 12
    s_add_u32 m0, s24, 131072
    s_nop 0
    buffer_load_dwordx4 v5, s[16:19], s26 offen offset:0 lds
    s_add_u32 m0, s24, 132096
    s_nop 0
    buffer_load_dwordx4 v14, s[16:19], s26 offen offset:0 lds
    s_add_u32 m0, s24, 139136
    s_nop 0
    buffer_load_dwordx4 v5, s[16:19], s26 offen offset:128 lds
    s_add_u32 m0, s24, 140160
    s_nop 0
    buffer_load_dwordx4 v14, s[16:19], s26 offen offset:128 lds
    s_add_u32 m0, s25, 131072
    s_nop 0
    buffer_load_dwordx4 v6, s[20:23], s27 offen offset:0 lds
    s_add_u32 m0, s25, 131072
    s_nop 0
    buffer_load_dwordx4 v6, s[20:23], s27 offen offset:1024 lds
    s_add_u32 m0, s25, 131072
    s_nop 0
    buffer_load_dwordx4 v6, s[20:23], s27 offen offset:2048 lds
    s_add_u32 m0, s25, 131072
    s_nop 0
    buffer_load_dwordx4 v6, s[20:23], s27 offen offset:3072 lds
    s_add_u32 s14, s14, 1
    s_cmp_eq_u32 s14, 14
    s_cselect_b32 s14, 0, s14
    s_waitcnt vmcnt(24)
    s_barrier
    s_lshl_b32 s26, s14, 8
    s_lshl_b32 s27, s14, 12
    s_add_u32 m0, s24, 0
    s_nop 0
    buffer_load_dwordx4 v5, s[16:19], s26 offen offset:0 lds
    s_add_u32 m0, s24, 1024
    s_nop 0
    buffer_load_dwordx4 v14, s[16:19], s26 offen offset:0 lds
    s_add_u32 m0, s24, 8064
    s_nop 0
    buffer_load_dwordx4 v5, s[16:19], s26 offen offset:128 lds
    s_add_u32 m0, s24, 9088
    s_nop 0
    buffer_load_dwordx4 v14, s[16:19], s26 offen offset:128 lds
    s_add_u32 m0, s25, 0
    s_nop 0
    buffer_load_dwordx4 v6, s[20:23], s27 offen offset:0 lds
    s_add_u32 m0, s25, 0
    s_nop 0
    buffer_load_dwordx4 v6, s[20:23], s27 offen offset:1024 lds
    s_add_u32 m0, s25, 0
    s_nop 0
    buffer_load_dwordx4 v6, s[20:23], s27 offen offset:2048 lds
    s_add_u32 m0, s25, 0
    s_nop 0
    buffer_load_dwordx4 v6, s[20:23], s27 offen offset:3072 lds
    s_add_u32 s14, s14, 1
    s_cmp_eq_u32 s14, 14
    s_cselect_b32 s14, 0, s14
    s_waitcnt vmcnt(24)
    s_barrier
    s_lshl_b32 s26, s14, 8
    s_lshl_b32 s27, s14, 12
    s_add_u32 m0, s24, 32768
    s_nop 0
    buffer_load_dwordx4 v5, s[16:19], s26 offen offset:0 lds
    s_add_u32 m0, s24, 33792
    s_nop 0
    buffer_load_dwordx4 v14, s[16:19], s26 offen offset:0 lds
    s_add_u32 m0, s24, 40832
    s_nop 0
    buffer_load_dwordx4 v5, s[16:19], s26 offen offset:128 lds
    s_add_u32 m0, s24, 41856
    s_nop 0
    buffer_load_dwordx4 v14, s[16:19], s26 offen offset:128 lds
    s_add_u32 m0, s25, 32768
    s_nop 0
    buffer_load_dwordx4 v6, s[20:23], s27 offen offset:0 lds
    s_add_u32 m0, s25, 32768
    s_nop 0
    buffer_load_dwordx4 v6, s[20:23], s27 offen offset:1024 lds
    s_add_u32 m0, s25, 32768
    s_nop 0
    buffer_load_dwordx4 v6, s[20:23], s27 offen offset:2048 lds
    s_add_u32 m0, s25, 32768
    s_nop 0
    buffer_load_dwordx4 v6, s[20:23], s27 offen offset:3072 lds
    s_add_u32 s14, s14, 1
    s_cmp_eq_u32 s14, 14
    s_cselect_b32 s14, 0, s14
    s_waitcnt vmcnt(24)
    s_barrier
    s_lshl_b32 s26, s14, 8
    s_lshl_b32 s27, s14, 12
    s_add_u32 m0, s24, 65536
    s_nop 0
    buffer_load_dwordx4 v5, s[16:19], s26 offen offset:0 lds
    s_add_u32 m0, s24, 66560
    s_nop 0
    buffer_load_dwordx4 v14, s[16:19], s26 offen offset:0 lds
    s_add_u32 m0, s24, 73600
    s_nop 0
    buffer_load_dwordx4 v5, s[16:19], s26 offen offset:128 lds
    s_add_u32 m0, s24, 74624
    s_nop 0
    buffer_load_dwordx4 v14, s[16:19], s26 offen offset:128 lds
    s_add_u32 m0, s25, 65536
    s_nop 0
    buffer_load_dwordx4 v6, s[20:23], s27 offen offset:0 lds
    s_add_u32 m0, s25, 65536
    s_nop 0
    buffer_load_dwordx4 v6, s[20:23], s27 offen offset:1024 lds
    s_add_u32 m0, s25, 65536
    s_nop 0
    buffer_load_dwordx4 v6, s[20:23], s27 offen offset:2048 lds
    s_add_u32 m0, s25, 65536
    s_nop 0
    buffer_load_dwordx4 v6, s[20:23], s27 offen offset:3072 lds
    s_add_u32 s14, s14, 1
    s_cmp_eq_u32 s14, 14
    s_cselect_b32 s14, 0, s14
    s_waitcnt vmcnt(24)
    s_barrier
    s_lshl_b32 s26, s14, 8
    s_lshl_b32 s27, s14, 12
    s_add_u32 m0, s24, 98304
    s_nop 0
    buffer_load_dwordx4 v5, s[16:19], s26 offen offset:0 lds
    s_add_u32 m0, s24, 99328
    s_nop 0
    buffer_load_dwordx4 v14, s[16:19], s26 offen offset:0 lds
    s_add_u32 m0, s24, 106368
    s_nop 0
    buffer_load_dwordx4 v5, s[16:19], s26 offen offset:128 lds
    s_add_u32 m0, s24, 107392
    s_nop 0
    buffer_load_dwordx4 v14, s[16:19], s26 offen offset:128 lds
    s_add_u32 m0, s25, 98304
    s_nop 0
    buffer_load_dwordx4 v6, s[20:23], s27 offen offset:0 lds
    s_add_u32 m0, s25, 98304
    s_nop 0
    buffer_load_dwordx4 v6, s[20:23], s27 offen offset:1024 lds
    s_add_u32 m0, s25, 98304
    s_nop 0
    buffer_load_dwordx4 v6, s[20:23], s27 offen offset:2048 lds
    s_add_u32 m0, s25, 98304
    s_nop 0
    buffer_load_dwordx4 v6, s[20:23], s27 offen offset:3072 lds
    s_add_u32 s14, s14, 1
    s_cmp_eq_u32 s14, 14
    s_cselect_b32 s14, 0, s14
    s_waitcnt vmcnt(24)
    s_barrier
    s_waitcnt vmcnt(16)
    s_barrier
    s_waitcnt vmcnt(8)
    s_barrier
    s_waitcnt vmcnt(0)
    s_barrier
    s_endpgm
K6_COMP:
    s_lshl_b32 s10, s12, 2
    s_add_u32 s10, s10, s13
    v_lshrrev_b32 v7, 3, v2
    v_lshlrev_b32 v7, 1, v7
    v_lshl_add_u32 v7, v3, 2, v7
    v_add_u32 v7, s3, v7
    v_mul_u32_u24 v7, 896, v7
    v_and_b32 v8, 7, v2
    v_lshl_add_u32 v7, v8, 2, v7
    s_lshl_b32 s11, s10, 5
    v_add_u32 v7, s11, v7
    s_lshl_b32 s11, s10, 6
    v_lshl_add_u32 v8, v8, 3, s11
    v_and_b32 v9, 6, v2
    v_xor_b32 v9, v9, v3
    v_lshlrev_b32 v9, 4, v9
    v_lshl_add_u32 v9, v2, 7, v9
    v_xor_b32 v10, 64, v9
    s_lshl_b32 s11, s13, 12
    s_add_u32 s11, s11, 16384
    v_lshl_add_u32 v11, v4, 4, s11
    v_add_u32 v12, 65536, v9
    v_add_u32 v13, 65536, v10
    v_add_u32 v14, 65536, v11
    v_add_u32 v15, 131072, v9
    v_add_u32 v16, 131072, v10
    v_add_u32 v17, 131072, v11
    v_cmp_gt_u32 s[28:29], 8, v2
    v_mov_b32 v32, 0
    v_mov_b32 v33, 0
    v_mov_b32 v34, 0
    v_mov_b32 v35, 0
    v_mov_b32 v36, 0
    v_mov_b32 v37, 0
    v_mov_b32 v38, 0
    v_mov_b32 v39, 0
    v_mov_b32 v40, 0
    v_mov_b32 v41, 0
    v_mov_b32 v42, 0
    v_mov_b32 v43, 0
    v_mov_b32 v44, 0
    v_mov_b32 v45, 0
    v_mov_b32 v46, 0
    v_mov_b32 v47, 0
    s_waitcnt lgkmcnt(0)
    s_add_u32 s22, s8, 25165824
    s_addc_u32 s23, s9, 0
    s_add_u32 s24, s8, 12582912
    s_addc_u32 s25, s9, 0
    s_add_u32 s26, s8, 8960
    s_addc_u32 s27, s9, 0
    s_barrier
    ds_read_b128 v[80:83], v11 offset:0
    ds_read_b128 v[64:67], v9 offset:0
    ds_read_b128 v[68:71], v9 offset:2048
    ds_read_b128 v[72:75], v9 offset:4096
    ds_read_b128 v[76:79], v9 offset:6144
    ds_read_b128 v[100:103], v11 offset:1024
    ds_read_b128 v[84:87], v10 offset:0
    ds_read_b128 v[88:91], v10 offset:2048
    ds_read_b128 v[92:95], v10 offset:4096
    ds_read_b128 v[96:99], v10 offset:6144
    ds_read_b128 v[120:123], v11 offset:2048
    ds_read_b128 v[104:107], v9 offset:8192
    ds_read_b128 v[108:111], v9 offset:10240
    ds_read_b128 v[112:115], v9 offset:12288
    ds_read_b128 v[116:119], v9 offset:14336
    ds_read_b128 v[140:143], v11 offset:3072
    ds_read_b128 v[124:127], v10 offset:8192
    ds_read_b128 v[128:131], v10 offset:10240
    ds_read_b128 v[132:135], v10 offset:12288
    ds_read_b128 v[136:139], v10 offset:14336
    s_waitcnt lgkmcnt(0)
    s_barrier
    v_mfma_f32_16x16x32_bf16 v[32:35], v[64:67], v[80:83], v[32:35]
    ds_read_b128 v[160:163], v11 offset:32768
    ds_read_b128 v[144:147], v9 offset:32768
    v_mfma_f32_16x16x32_bf16 v[36:39], v[68:71], v[80:83], v[36:39]
    ds_read_b128 v[148:151], v9 offset:34816
    v_mfma_f32_16x16x32_bf16 v[40:43], v[72:75], v[80:83], v[40:43]
    ds_read_b128 v[152:155], v9 offset:36864
    v_mfma_f32_16x16x32_bf16 v[44:47], v[76:79], v[80:83], v[44:47]
    ds_read_b128 v[156:159], v9 offset:38912
    v_mfma_f32_16x16x32_bf16 v[32:35], v[84:87], v[100:103], v[32:35]
    ds_read_b128 v[180:183], v11 offset:33792
    ds_read_b128 v[164:167], v10 offset:32768
    v_mfma_f32_16x16x32_bf16 v[36:39], v[88:91], v[100:103], v[36:39]
    ds_read_b128 v[168:171], v10 offset:34816
    v_mfma_f32_16x16x32_bf16 v[40:43], v[92:95], v[100:103], v[40:43]
    ds_read_b128 v[172:175], v10 offset:36864
    v_mfma_f32_16x16x32_bf16 v[44:47], v[96:99], v[100:103], v[44:47]
    ds_read_b128 v[176:179], v10 offset:38912
    v_mfma_f32_16x16x32_bf16 v[32:35], v[104:107], v[120:123], v[32:35]
    ds_read_b128 v[200:203], v11 offset:34816
    ds_read_b128 v[184:187], v9 offset:40960
    v_mfma_f32_16x16x32_bf16 v[36:39], v[108:111], v[120:123], v[36:39]
    ds_read_b128 v[188:191], v9 offset:43008
    v_mfma_f32_16x16x32_bf16 v[40:43], v[112:115], v[120:123], v[40:43]
    ds_read_b128 v[192:195], v9 offset:45056
    v_mfma_f32_16x16x32_bf16 v[44:47], v[116:119], v[120:123], v[44:47]
    ds_read_b128 v[196:199], v9 offset:47104
    v_mfma_f32_16x16x32_bf16 v[32:35], v[124:127], v[140:143], v[32:35]
    ds_read_b128 v[220:223], v11 offset:35840
    ds_read_b128 v[204:207], v10 offset:40960
    v_mfma_f32_16x16x32_bf16 v[36:39], v[128:131], v[140:143], v[36:39]
    ds_read_b128 v[208:211], v10 offset:43008
    v_mfma_f32_16x16x32_bf16 v[40:43], v[132:135], v[140:143], v[40:43]
    ds_read_b128 v[212:215], v10 offset:45056
    v_mfma_f32_16x16x32_bf16 v[44:47], v[136:139], v[140:143], v[44:47]
    ds_read_b128 v[216:219], v10 offset:47104
    s_waitcnt lgkmcnt(0)
    s_barrier
    v_mfma_f32_16x16x32_bf16 v[32:35], v[144:147], v[160:163], v[32:35]
    ds_read_b128 v[80:83], v14 offset:0
    ds_read_b128 v[64:67], v12 offset:0
    v_mfma_f32_16x16x32_bf16 v[36:39], v[148:151], v[160:163], v[36:39]
    ds_read_b128 v[68:71], v12 offset:2048
    v_mfma_f32_16x16x32_bf16 v[40:43], v[152:155], v[160:163], v[40:43]
    ds_read_b128 v[72:75], v12 offset:4096
    v_mfma_f32_16x16x32_bf16 v[44:47], v[156:159], v[160:163], v[44:47]
    ds_read_b128 v[76:79], v12 offset:6144
    v_mfma_f32_16x16x32_bf16 v[32:35], v[164:167], v[180:183], v[32:35]
    ds_read_b128 v[100:103], v14 offset:1024
    ds_read_b128 v[84:87], v13 offset:0
    v_mfma_f32_16x16x32_bf16 v[36:39], v[168:171], v[180:183], v[36:39]
    ds_read_b128 v[88:91], v13 offset:2048
    v_mfma_f32_16x16x32_bf16 v[40:43], v[172:175], v[180:183], v[40:43]
    ds_read_b128 v[92:95], v13 offset:4096
    v_mfma_f32_16x16x32_bf16 v[44:47], v[176:179], v[180:183], v[44:47]
    ds_read_b128 v[96:99], v13 offset:6144
    v_mfma_f32_16x16x32_bf16 v[32:35], v[184:187], v[200:203], v[32:35]
    ds_read_b128 v[120:123], v14 offset:2048
    ds_read_b128 v[104:107], v12 offset:8192
    v_mfma_f32_16x16x32_bf16 v[36:39], v[188:191], v[200:203], v[36:39]
    ds_read_b128 v[108:111], v12 offset:10240
    v_mfma_f32_16x16x32_bf16 v[40:43], v[192:195], v[200:203], v[40:43]
    ds_read_b128 v[112:115], v12 offset:12288
    v_mfma_f32_16x16x32_bf16 v[44:47], v[196:199], v[200:203], v[44:47]
    ds_read_b128 v[116:119], v12 offset:14336
    v_mfma_f32_16x16x32_bf16 v[32:35], v[204:207], v[220:223], v[32:35]
    ds_read_b128 v[140:143], v14 offset:3072
    ds_read_b128 v[124:127], v13 offset:8192
    v_mfma_f32_16x16x32_bf16 v[36:39], v[208:211], v[220:223], v[36:39]
    ds_read_b128 v[128:131], v13 offset:10240
    v_mfma_f32_16x16x32_bf16 v[40:43], v[212:215], v[220:223], v[40:43]
    ds_read_b128 v[132:135], v13 offset:12288
    v_mfma_f32_16x16x32_bf16 v[44:47], v[216:219], v[220:223], v[44:47]
    ds_read_b128 v[136:139], v13 offset:14336
    s_waitcnt lgkmcnt(0)
    s_barrier
    v_mfma_f32_16x16x32_bf16 v[32:35], v[64:67], v[80:83], v[32:35]
    ds_read_b128 v[160:163], v14 offset:32768
    ds_read_b128 v[144:147], v12 offset:32768
    v_mfma_f32_16x16x32_bf16 v[36:39], v[68:71], v[80:83], v[36:39]
    ds_read_b128 v[148:151], v12 offset:34816
    v_mfma_f32_16x16x32_bf16 v[40:43], v[72:75], v[80:83], v[40:43]
    ds_read_b128 v[152:155], v12 offset:36864
    v_mfma_f32_16x16x32_bf16 v[44:47], v[76:79], v[80:83], v[44:47]
    ds_read_b128 v[156:159], v12 offset:38912
    v_mfma_f32_16x16x32_bf16 v[32:35], v[84:87], v[100:103], v[32:35]
    ds_read_b128 v[180:183], v14 offset:33792
    ds_read_b128 v[164:167], v13 offset:32768
    v_mfma_f32_16x16x32_bf16 v[36:39], v[88:91], v[100:103], v[36:39]
    ds_read_b128 v[168:171], v13 offset:34816
    v_mfma_f32_16x16x32_bf16 v[40:43], v[92:95], v[100:103], v[40:43]
    ds_read_b128 v[172:175], v13 offset:36864
    v_mfma_f32_16x16x32_bf16 v[44:47], v[96:99], v[100:103], v[44:47]
    ds_read_b128 v[176:179], v13 offset:38912
    v_mfma_f32_16x16x32_bf16 v[32:35], v[104:107], v[120:123], v[32:35]
    ds_read_b128 v[200:203], v14 offset:34816
    ds_read_b128 v[184:187], v12 offset:40960
    v_mfma_f32_16x16x32_bf16 v[36:39], v[108:111], v[120:123], v[36:39]
    ds_read_b128 v[188:191], v12 offset:43008
    v_mfma_f32_16x16x32_bf16 v[40:43], v[112:115], v[120:123], v[40:43]
    ds_read_b128 v[192:195], v12 offset:45056
    v_mfma_f32_16x16x32_bf16 v[44:47], v[116:119], v[120:123], v[44:47]
    ds_read_b128 v[196:199], v12 offset:47104
    v_mfma_f32_16x16x32_bf16 v[32:35], v[124:127], v[140:143], v[32:35]
    ds_read_b128 v[220:223], v14 offset:35840
    ds_read_b128 v[204:207], v13 offset:40960
    v_mfma_f32_16x16x32_bf16 v[36:39], v[128:131], v[140:143], v[36:39]
    ds_read_b128 v[208:211], v13 offset:43008
    v_mfma_f32_16x16x32_bf16 v[40:43], v[132:135], v[140:143], v[40:43]
    ds_read_b128 v[212:215], v13 offset:45056
    v_mfma_f32_16x16x32_bf16 v[44:47], v[136:139], v[140:143], v[44:47]
    ds_read_b128 v[216:219], v13 offset:47104
    s_waitcnt lgkmcnt(0)
    s_barrier
    v_mfma_f32_16x16x32_bf16 v[32:35], v[144:147], v[160:163], v[32:35]
    ds_read_b128 v[80:83], v17 offset:0
    ds_read_b128 v[64:67], v15 offset:0
    v_mfma_f32_16x16x32_bf16 v[36:39], v[148:151], v[160:163], v[36:39]
    ds_read_b128 v[68:71], v15 offset:2048
    v_mfma_f32_16x16x32_bf16 v[40:43], v[152:155], v[160:163], v[40:43]
    ds_read_b128 v[72:75], v15 offset:4096
    v_mfma_f32_16x16x32_bf16 v[44:47], v[156:159], v[160:163], v[44:47]
    ds_read_b128 v[76:79], v15 offset:6144
    v_mfma_f32_16x16x32_bf16 v[32:35], v[164:167], v[180:183], v[32:35]
    ds_read_b128 v[100:103], v17 offset:1024
    ds_read_b128 v[84:87], v16 offset:0
    v_mfma_f32_16x16x32_bf16 v[36:39], v[168:171], v[180:183], v[36:39]
    ds_read_b128 v[88:91], v16 offset:2048
    v_mfma_f32_16x16x32_bf16 v[40:43], v[172:175], v[180:183], v[40:43]
    ds_read_b128 v[92:95], v16 offset:4096
    v_mfma_f32_16x16x32_bf16 v[44:47], v[176:179], v[180:183], v[44:47]
    ds_read_b128 v[96:99], v16 offset:6144
    v_mfma_f32_16x16x32_bf16 v[32:35], v[184:187], v[200:203], v[32:35]
    ds_read_b128 v[120:123], v17 offset:2048
    ds_read_b128 v[104:107], v15 offset:8192
    v_mfma_f32_16x16x32_bf16 v[36:39], v[188:191], v[200:203], v[36:39]
    ds_read_b128 v[108:111], v15 offset:10240
    v_mfma_f32_16x16x32_bf16 v[40:43], v[192:195], v[200:203], v[40:43]
    ds_read_b128 v[112:115], v15 offset:12288
    v_mfma_f32_16x16x32_bf16 v[44:47], v[196:199], v[200:203], v[44:47]
    ds_read_b128 v[116:119], v15 offset:14336
    v_mfma_f32_16x16x32_bf16 v[32:35], v[204:207], v[220:223], v[32:35]
    ds_read_b128 v[140:143], v17 offset:3072
    ds_read_b128 v[124:127], v16 offset:8192
    v_mfma_f32_16x16x32_bf16 v[36:39], v[208:211], v[220:223], v[36:39]
    ds_read_b128 v[128:131], v16 offset:10240
    v_mfma_f32_16x16x32_bf16 v[40:43], v[212:215], v[220:223], v[40:43]
    ds_read_b128 v[132:135], v16 offset:12288
    v_mfma_f32_16x16x32_bf16 v[44:47], v[216:219], v[220:223], v[44:47]
    ds_read_b128 v[136:139], v16 offset:14336
    s_waitcnt lgkmcnt(0)
    s_barrier
    v_mfma_f32_16x16x32_bf16 v[32:35], v[64:67], v[80:83], v[32:35]
    ds_read_b128 v[160:163], v11 offset:0
    ds_read_b128 v[144:147], v9 offset:0
    v_mfma_f32_16x16x32_bf16 v[36:39], v[68:71], v[80:83], v[36:39]
    ds_read_b128 v[148:151], v9 offset:2048
    v_mfma_f32_16x16x32_bf16 v[40:43], v[72:75], v[80:83], v[40:43]
    ds_read_b128 v[152:155], v9 offset:4096
    v_mfma_f32_16x16x32_bf16 v[44:47], v[76:79], v[80:83], v[44:47]
    ds_read_b128 v[156:159], v9 offset:6144
    v_mfma_f32_16x16x32_bf16 v[32:35], v[84:87], v[100:103], v[32:35]
    ds_read_b128 v[180:183], v11 offset:1024
    ds_read_b128 v[164:167], v10 offset:0
    v_mfma_f32_16x16x32_bf16 v[36:39], v[88:91], v[100:103], v[36:39]
    ds_read_b128 v[168:171], v10 offset:2048
    v_mfma_f32_16x16x32_bf16 v[40:43], v[92:95], v[100:103], v[40:43]
    ds_read_b128 v[172:175], v10 offset:4096
    v_mfma_f32_16x16x32_bf16 v[44:47], v[96:99], v[100:103], v[44:47]
    ds_read_b128 v[176:179], v10 offset:6144
    v_mfma_f32_16x16x32_bf16 v[32:35], v[104:107], v[120:123], v[32:35]
    ds_read_b128 v[200:203], v11 offset:2048
    ds_read_b128 v[184:187], v9 offset:8192
    v_mfma_f32_16x16x32_bf16 v[36:39], v[108:111], v[120:123], v[36:39]
    ds_read_b128 v[188:191], v9 offset:10240
    v_mfma_f32_16x16x32_bf16 v[40:43], v[112:115], v[120:123], v[40:43]
    ds_read_b128 v[192:195], v9 offset:12288
    v_mfma_f32_16x16x32_bf16 v[44:47], v[116:119], v[120:123], v[44:47]
    ds_read_b128 v[196:199], v9 offset:14336
    v_mfma_f32_16x16x32_bf16 v[32:35], v[124:127], v[140:143], v[32:35]
    ds_read_b128 v[220:223], v11 offset:3072
    ds_read_b128 v[204:207], v10 offset:8192
    v_mfma_f32_16x16x32_bf16 v[36:39], v[128:131], v[140:143], v[36:39]
    ds_read_b128 v[208:211], v10 offset:10240
    v_mfma_f32_16x16x32_bf16 v[40:43], v[132:135], v[140:143], v[40:43]
    ds_read_b128 v[212:215], v10 offset:12288
    v_mfma_f32_16x16x32_bf16 v[44:47], v[136:139], v[140:143], v[44:47]
    ds_read_b128 v[216:219], v10 offset:14336
    s_waitcnt lgkmcnt(0)
    s_barrier
    v_mfma_f32_16x16x32_bf16 v[32:35], v[144:147], v[160:163], v[32:35]
    ds_read_b128 v[80:83], v11 offset:32768
    ds_read_b128 v[64:67], v9 offset:32768
    v_mfma_f32_16x16x32_bf16 v[36:39], v[148:151], v[160:163], v[36:39]
    ds_read_b128 v[68:71], v9 offset:34816
    v_mfma_f32_16x16x32_bf16 v[40:43], v[152:155], v[160:163], v[40:43]
    ds_read_b128 v[72:75], v9 offset:36864
    v_mfma_f32_16x16x32_bf16 v[44:47], v[156:159], v[160:163], v[44:47]
    ds_read_b128 v[76:79], v9 offset:38912
    v_mfma_f32_16x16x32_bf16 v[32:35], v[164:167], v[180:183], v[32:35]
    ds_read_b128 v[100:103], v11 offset:33792
    ds_read_b128 v[84:87], v10 offset:32768
    v_mfma_f32_16x16x32_bf16 v[36:39], v[168:171], v[180:183], v[36:39]
    ds_read_b128 v[88:91], v10 offset:34816
    v_mfma_f32_16x16x32_bf16 v[40:43], v[172:175], v[180:183], v[40:43]
    ds_read_b128 v[92:95], v10 offset:36864
    v_mfma_f32_16x16x32_bf16 v[44:47], v[176:179], v[180:183], v[44:47]
    ds_read_b128 v[96:99], v10 offset:38912
    v_mfma_f32_16x16x32_bf16 v[32:35], v[184:187], v[200:203], v[32:35]
    ds_read_b128 v[120:123], v11 offset:34816
    ds_read_b128 v[104:107], v9 offset:40960
    v_mfma_f32_16x16x32_bf16 v[36:39], v[188:191], v[200:203], v[36:39]
    ds_read_b128 v[108:111], v9 offset:43008
    v_mfma_f32_16x16x32_bf16 v[40:43], v[192:195], v[200:203], v[40:43]
    ds_read_b128 v[112:115], v9 offset:45056
    v_mfma_f32_16x16x32_bf16 v[44:47], v[196:199], v[200:203], v[44:47]
    ds_read_b128 v[116:119], v9 offset:47104
    v_mfma_f32_16x16x32_bf16 v[32:35], v[204:207], v[220:223], v[32:35]
    ds_read_b128 v[140:143], v11 offset:35840
    ds_read_b128 v[124:127], v10 offset:40960
    v_mfma_f32_16x16x32_bf16 v[36:39], v[208:211], v[220:223], v[36:39]
    ds_read_b128 v[128:131], v10 offset:43008
    v_mfma_f32_16x16x32_bf16 v[40:43], v[212:215], v[220:223], v[40:43]
    ds_read_b128 v[132:135], v10 offset:45056
    v_mfma_f32_16x16x32_bf16 v[44:47], v[216:219], v[220:223], v[44:47]
    ds_read_b128 v[136:139], v10 offset:47104
    s_waitcnt lgkmcnt(0)
    s_barrier
    v_mfma_f32_16x16x32_bf16 v[32:35], v[64:67], v[80:83], v[32:35]
    ds_read_b128 v[160:163], v14 offset:0
    ds_read_b128 v[144:147], v12 offset:0
    v_mfma_f32_16x16x32_bf16 v[36:39], v[68:71], v[80:83], v[36:39]
    ds_read_b128 v[148:151], v12 offset:2048
    v_mfma_f32_16x16x32_bf16 v[40:43], v[72:75], v[80:83], v[40:43]
    ds_read_b128 v[152:155], v12 offset:4096
    v_mfma_f32_16x16x32_bf16 v[44:47], v[76:79], v[80:83], v[44:47]
    ds_read_b128 v[156:159], v12 offset:6144
    v_mfma_f32_16x16x32_bf16 v[32:35], v[84:87], v[100:103], v[32:35]
    ds_read_b128 v[180:183], v14 offset:1024
    ds_read_b128 v[164:167], v13 offset:0
    v_mfma_f32_16x16x32_bf16 v[36:39], v[88:91], v[100:103], v[36:39]
    ds_read_b128 v[168:171], v13 offset:2048
    v_mfma_f32_16x16x32_bf16 v[40:43], v[92:95], v[100:103], v[40:43]
    ds_read_b128 v[172:175], v13 offset:4096
    v_mfma_f32_16x16x32_bf16 v[44:47], v[96:99], v[100:103], v[44:47]
    ds_read_b128 v[176:179], v13 offset:6144
    v_mfma_f32_16x16x32_bf16 v[32:35], v[104:107], v[120:123], v[32:35]
    ds_read_b128 v[200:203], v14 offset:2048
    ds_read_b128 v[184:187], v12 offset:8192
    v_mfma_f32_16x16x32_bf16 v[36:39], v[108:111], v[120:123], v[36:39]
    ds_read_b128 v[188:191], v12 offset:10240
    v_mfma_f32_16x16x32_bf16 v[40:43], v[112:115], v[120:123], v[40:43]
    ds_read_b128 v[192:195], v12 offset:12288
    v_mfma_f32_16x16x32_bf16 v[44:47], v[116:119], v[120:123], v[44:47]
    ds_read_b128 v[196:199], v12 offset:14336
    v_mfma_f32_16x16x32_bf16 v[32:35], v[124:127], v[140:143], v[32:35]
    ds_read_b128 v[220:223], v14 offset:3072
    ds_read_b128 v[204:207], v13 offset:8192
    v_mfma_f32_16x16x32_bf16 v[36:39], v[128:131], v[140:143], v[36:39]
    ds_read_b128 v[208:211], v13 offset:10240
    v_mfma_f32_16x16x32_bf16 v[40:43], v[132:135], v[140:143], v[40:43]
    ds_read_b128 v[212:215], v13 offset:12288
    v_mfma_f32_16x16x32_bf16 v[44:47], v[136:139], v[140:143], v[44:47]
    ds_read_b128 v[216:219], v13 offset:14336
    s_waitcnt lgkmcnt(0)
    s_barrier
    v_mfma_f32_16x16x32_bf16 v[32:35], v[144:147], v[160:163], v[32:35]
    ds_read_b128 v[80:83], v14 offset:32768
    ds_read_b128 v[64:67], v12 offset:32768
    v_mfma_f32_16x16x32_bf16 v[36:39], v[148:151], v[160:163], v[36:39]
    ds_read_b128 v[68:71], v12 offset:34816
    v_mfma_f32_16x16x32_bf16 v[40:43], v[152:155], v[160:163], v[40:43]
    ds_read_b128 v[72:75], v12 offset:36864
    v_mfma_f32_16x16x32_bf16 v[44:47], v[156:159], v[160:163], v[44:47]
    ds_read_b128 v[76:79], v12 offset:38912
    v_mfma_f32_16x16x32_bf16 v[32:35], v[164:167], v[180:183], v[32:35]
    ds_read_b128 v[100:103], v14 offset:33792
    ds_read_b128 v[84:87], v13 offset:32768
    v_mfma_f32_16x16x32_bf16 v[36:39], v[168:171], v[180:183], v[36:39]
    ds_read_b128 v[88:91], v13 offset:34816
    v_mfma_f32_16x16x32_bf16 v[40:43], v[172:175], v[180:183], v[40:43]
    ds_read_b128 v[92:95], v13 offset:36864
    v_mfma_f32_16x16x32_bf16 v[44:47], v[176:179], v[180:183], v[44:47]
    ds_read_b128 v[96:99], v13 offset:38912
    v_mfma_f32_16x16x32_bf16 v[32:35], v[184:187], v[200:203], v[32:35]
    ds_read_b128 v[120:123], v14 offset:34816
    ds_read_b128 v[104:107], v12 offset:40960
    v_mfma_f32_16x16x32_bf16 v[36:39], v[188:191], v[200:203], v[36:39]
    ds_read_b128 v[108:111], v12 offset:43008
    v_mfma_f32_16x16x32_bf16 v[40:43], v[192:195], v[200:203], v[40:43]
    ds_read_b128 v[112:115], v12 offset:45056
    v_mfma_f32_16x16x32_bf16 v[44:47], v[196:199], v[200:203], v[44:47]
    ds_read_b128 v[116:119], v12 offset:47104
    v_mfma_f32_16x16x32_bf16 v[32:35], v[204:207], v[220:223], v[32:35]
    ds_read_b128 v[140:143], v14 offset:35840
    ds_read_b128 v[124:127], v13 offset:40960
    v_mfma_f32_16x16x32_bf16 v[36:39], v[208:211], v[220:223], v[36:39]
    ds_read_b128 v[128:131], v13 offset:43008
    v_mfma_f32_16x16x32_bf16 v[40:43], v[212:215], v[220:223], v[40:43]
    ds_read_b128 v[132:135], v13 offset:45056
    v_mfma_f32_16x16x32_bf16 v[44:47], v[216:219], v[220:223], v[44:47]
    ds_read_b128 v[136:139], v13 offset:47104
    s_waitcnt lgkmcnt(0)
    s_barrier
    v_mov_b32 v18, v7
    global_load_dword v224, v18, s[22:23] offset:0
    global_load_dword v232, v18, s[24:25] offset:0
    global_load_dword v225, v18, s[22:23] offset:896
    global_load_dword v233, v18, s[24:25] offset:896
    v_add_u32 v18, 14336, v18
    global_load_dword v226, v18, s[22:23] offset:0
    global_load_dword v234, v18, s[24:25] offset:0
    global_load_dword v227, v18, s[22:23] offset:896
    global_load_dword v235, v18, s[24:25] offset:896
    v_add_u32 v18, 14336, v18
    global_load_dword v228, v18, s[22:23] offset:0
    global_load_dword v236, v18, s[24:25] offset:0
    global_load_dword v229, v18, s[22:23] offset:896
    global_load_dword v237, v18, s[24:25] offset:896
    v_add_u32 v18, 14336, v18
    global_load_dword v230, v18, s[22:23] offset:0
    global_load_dword v238, v18, s[24:25] offset:0
    global_load_dword v231, v18, s[22:23] offset:896
    global_load_dword v239, v18, s[24:25] offset:896
    global_load_dwordx2 v[240:241], v8, s[26:27]
    v_mfma_f32_16x16x32_bf16 v[32:35], v[64:67], v[80:83], v[32:35]
    ds_read_b128 v[160:163], v17 offset:0
    ds_read_b128 v[144:147], v15 offset:0
    v_mfma_f32_16x16x32_bf16 v[36:39], v[68:71], v[80:83], v[36:39]
    ds_read_b128 v[148:151], v15 offset:2048
    v_mfma_f32_16x16x32_bf16 v[40:43], v[72:75], v[80:83], v[40:43]
    ds_read_b128 v[152:155], v15 offset:4096
    v_mfma_f32_16x16x32_bf16 v[44:47], v[76:79], v[80:83], v[44:47]
    ds_read_b128 v[156:159], v15 offset:6144
    v_mfma_f32_16x16x32_bf16 v[32:35], v[84:87], v[100:103], v[32:35]
    ds_read_b128 v[180:183], v17 offset:1024
    ds_read_b128 v[164:167], v16 offset:0
    v_mfma_f32_16x16x32_bf16 v[36:39], v[88:91], v[100:103], v[36:39]
    ds_read_b128 v[168:171], v16 offset:2048
    v_mfma_f32_16x16x32_bf16 v[40:43], v[92:95], v[100:103], v[40:43]
    ds_read_b128 v[172:175], v16 offset:4096
    v_mfma_f32_16x16x32_bf16 v[44:47], v[96:99], v[100:103], v[44:47]
    ds_read_b128 v[176:179], v16 offset:6144
    v_mfma_f32_16x16x32_bf16 v[32:35], v[104:107], v[120:123], v[32:35]
    ds_read_b128 v[200:203], v17 offset:2048
    ds_read_b128 v[184:187], v15 offset:8192
    v_mfma_f32_16x16x32_bf16 v[36:39], v[108:111], v[120:123], v[36:39]
    ds_read_b128 v[188:191], v15 offset:10240
    v_mfma_f32_16x16x32_bf16 v[40:43], v[112:115], v[120:123], v[40:43]
    ds_read_b128 v[192:195], v15 offset:12288
    v_mfma_f32_16x16x32_bf16 v[44:47], v[116:119], v[120:123], v[44:47]
    ds_read_b128 v[196:199], v15 offset:14336
    v_mfma_f32_16x16x32_bf16 v[32:35], v[124:127], v[140:143], v[32:35]
    ds_read_b128 v[220:223], v17 offset:3072
    ds_read_b128 v[204:207], v16 offset:8192
    v_mfma_f32_16x16x32_bf16 v[36:39], v[128:131], v[140:143], v[36:39]
    ds_read_b128 v[208:211], v16 offset:10240
    v_mfma_f32_16x16x32_bf16 v[40:43], v[132:135], v[140:143], v[40:43]
    ds_read_b128 v[212:215], v16 offset:12288
    v_mfma_f32_16x16x32_bf16 v[44:47], v[136:139], v[140:143], v[44:47]
    ds_read_b128 v[216:219], v16 offset:14336
    s_waitcnt lgkmcnt(0)
    s_barrier
    v_mfma_f32_16x16x32_bf16 v[32:35], v[144:147], v[160:163], v[32:35]
    ds_read_b128 v[80:83], v11 offset:0
    ds_read_b128 v[64:67], v9 offset:0
    v_mfma_f32_16x16x32_bf16 v[36:39], v[148:151], v[160:163], v[36:39]
    ds_read_b128 v[68:71], v9 offset:2048
    v_mfma_f32_16x16x32_bf16 v[40:43], v[152:155], v[160:163], v[40:43]
    ds_read_b128 v[72:75], v9 offset:4096
    v_mfma_f32_16x16x32_bf16 v[44:47], v[156:159], v[160:163], v[44:47]
    ds_read_b128 v[76:79], v9 offset:6144
    v_mfma_f32_16x16x32_bf16 v[32:35], v[164:167], v[180:183], v[32:35]
    ds_read_b128 v[100:103], v11 offset:1024
    ds_read_b128 v[84:87], v10 offset:0
    v_mfma_f32_16x16x32_bf16 v[36:39], v[168:171], v[180:183], v[36:39]
    ds_read_b128 v[88:91], v10 offset:2048
    v_mfma_f32_16x16x32_bf16 v[40:43], v[172:175], v[180:183], v[40:43]
    ds_read_b128 v[92:95], v10 offset:4096
    v_mfma_f32_16x16x32_bf16 v[44:47], v[176:179], v[180:183], v[44:47]
    ds_read_b128 v[96:99], v10 offset:6144
    v_mfma_f32_16x16x32_bf16 v[32:35], v[184:187], v[200:203], v[32:35]
    ds_read_b128 v[120:123], v11 offset:2048
    ds_read_b128 v[104:107], v9 offset:8192
    v_mfma_f32_16x16x32_bf16 v[36:39], v[188:191], v[200:203], v[36:39]
    ds_read_b128 v[108:111], v9 offset:10240
    v_mfma_f32_16x16x32_bf16 v[40:43], v[192:195], v[200:203], v[40:43]
    ds_read_b128 v[112:115], v9 offset:12288
    v_mfma_f32_16x16x32_bf16 v[44:47], v[196:199], v[200:203], v[44:47]
    ds_read_b128 v[116:119], v9 offset:14336
    v_mfma_f32_16x16x32_bf16 v[32:35], v[204:207], v[220:223], v[32:35]
    ds_read_b128 v[140:143], v11 offset:3072
    ds_read_b128 v[124:127], v10 offset:8192
    v_mfma_f32_16x16x32_bf16 v[36:39], v[208:211], v[220:223], v[36:39]
    ds_read_b128 v[128:131], v10 offset:10240
    v_mfma_f32_16x16x32_bf16 v[40:43], v[212:215], v[220:223], v[40:43]
    ds_read_b128 v[132:135], v10 offset:12288
    v_mfma_f32_16x16x32_bf16 v[44:47], v[216:219], v[220:223], v[44:47]
    ds_read_b128 v[136:139], v10 offset:14336
    s_waitcnt lgkmcnt(0)
    s_barrier
    v_mfma_f32_16x16x32_bf16 v[32:35], v[64:67], v[80:83], v[32:35]
    ds_read_b128 v[160:163], v11 offset:32768
    ds_read_b128 v[144:147], v9 offset:32768
    v_mfma_f32_16x16x32_bf16 v[36:39], v[68:71], v[80:83], v[36:39]
    ds_read_b128 v[148:151], v9 offset:34816
    v_mfma_f32_16x16x32_bf16 v[40:43], v[72:75], v[80:83], v[40:43]
    ds_read_b128 v[152:155], v9 offset:36864
    v_mfma_f32_16x16x32_bf16 v[44:47], v[76:79], v[80:83], v[44:47]
    ds_read_b128 v[156:159], v9 offset:38912
    v_mfma_f32_16x16x32_bf16 v[32:35], v[84:87], v[100:103], v[32:35]
    ds_read_b128 v[180:183], v11 offset:33792
    ds_read_b128 v[164:167], v10 offset:32768
    v_mfma_f32_16x16x32_bf16 v[36:39], v[88:91], v[100:103], v[36:39]
    ds_read_b128 v[168:171], v10 offset:34816
    v_mfma_f32_16x16x32_bf16 v[40:43], v[92:95], v[100:103], v[40:43]
    ds_read_b128 v[172:175], v10 offset:36864
    v_mfma_f32_16x16x32_bf16 v[44:47], v[96:99], v[100:103], v[44:47]
    ds_read_b128 v[176:179], v10 offset:38912
    v_mfma_f32_16x16x32_bf16 v[32:35], v[104:107], v[120:123], v[32:35]
    ds_read_b128 v[200:203], v11 offset:34816
    ds_read_b128 v[184:187], v9 offset:40960
    v_mfma_f32_16x16x32_bf16 v[36:39], v[108:111], v[120:123], v[36:39]
    ds_read_b128 v[188:191], v9 offset:43008
    v_mfma_f32_16x16x32_bf16 v[40:43], v[112:115], v[120:123], v[40:43]
    ds_read_b128 v[192:195], v9 offset:45056
    v_mfma_f32_16x16x32_bf16 v[44:47], v[116:119], v[120:123], v[44:47]
    ds_read_b128 v[196:199], v9 offset:47104
    v_mfma_f32_16x16x32_bf16 v[32:35], v[124:127], v[140:143], v[32:35]
    ds_read_b128 v[220:223], v11 offset:35840
    ds_read_b128 v[204:207], v10 offset:40960
    v_mfma_f32_16x16x32_bf16 v[36:39], v[128:131], v[140:143], v[36:39]
    ds_read_b128 v[208:211], v10 offset:43008
    v_mfma_f32_16x16x32_bf16 v[40:43], v[132:135], v[140:143], v[40:43]
    ds_read_b128 v[212:215], v10 offset:45056
    v_mfma_f32_16x16x32_bf16 v[44:47], v[136:139], v[140:143], v[44:47]
    ds_read_b128 v[216:219], v10 offset:47104
    s_waitcnt lgkmcnt(0)
    s_barrier
    v_mfma_f32_16x16x32_bf16 v[32:35], v[144:147], v[160:163], v[32:35]
    ds_read_b128 v[80:83], v14 offset:0
    ds_read_b128 v[64:67], v12 offset:0
    v_mfma_f32_16x16x32_bf16 v[36:39], v[148:151], v[160:163], v[36:39]
    ds_read_b128 v[68:71], v12 offset:2048
    v_mfma_f32_16x16x32_bf16 v[40:43], v[152:155], v[160:163], v[40:43]
    ds_read_b128 v[72:75], v12 offset:4096
    v_mfma_f32_16x16x32_bf16 v[44:47], v[156:159], v[160:163], v[44:47]
    ds_read_b128 v[76:79], v12 offset:6144
    v_mfma_f32_16x16x32_bf16 v[32:35], v[164:167], v[180:183], v[32:35]
    ds_read_b128 v[100:103], v14 offset:1024
    ds_read_b128 v[84:87], v13 offset:0
    v_mfma_f32_16x16x32_bf16 v[36:39], v[168:171], v[180:183], v[36:39]
    ds_read_b128 v[88:91], v13 offset:2048
    v_mfma_f32_16x16x32_bf16 v[40:43], v[172:175], v[180:183], v[40:43]
    ds_read_b128 v[92:95], v13 offset:4096
    v_mfma_f32_16x16x32_bf16 v[44:47], v[176:179], v[180:183], v[44:47]
    ds_read_b128 v[96:99], v13 offset:6144
    v_mfma_f32_16x16x32_bf16 v[32:35], v[184:187], v[200:203], v[32:35]
    ds_read_b128 v[120:123], v14 offset:2048
    ds_read_b128 v[104:107], v12 offset:8192
    v_mfma_f32_16x16x32_bf16 v[36:39], v[188:191], v[200:203], v[36:39]
    ds_read_b128 v[108:111], v12 offset:10240
    v_mfma_f32_16x16x32_bf16 v[40:43], v[192:195], v[200:203], v[40:43]
    ds_read_b128 v[112:115], v12 offset:12288
    v_mfma_f32_16x16x32_bf16 v[44:47], v[196:199], v[200:203], v[44:47]
    ds_read_b128 v[116:119], v12 offset:14336
    v_mfma_f32_16x16x32_bf16 v[32:35], v[204:207], v[220:223], v[32:35]
    ds_read_b128 v[140:143], v14 offset:3072
    ds_read_b128 v[124:127], v13 offset:8192
    v_mfma_f32_16x16x32_bf16 v[36:39], v[208:211], v[220:223], v[36:39]
    ds_read_b128 v[128:131], v13 offset:10240
    v_mfma_f32_16x16x32_bf16 v[40:43], v[212:215], v[220:223], v[40:43]
    ds_read_b128 v[132:135], v13 offset:12288
    v_mfma_f32_16x16x32_bf16 v[44:47], v[216:219], v[220:223], v[44:47]
    ds_read_b128 v[136:139], v13 offset:14336
    s_waitcnt lgkmcnt(0)
    s_barrier
    v_mfma_f32_16x16x32_bf16 v[32:35], v[64:67], v[80:83], v[32:35]
    ds_read_b128 v[160:163], v14 offset:32768
    ds_read_b128 v[144:147], v12 offset:32768
    v_mfma_f32_16x16x32_bf16 v[36:39], v[68:71], v[80:83], v[36:39]
    ds_read_b128 v[148:151], v12 offset:34816
    v_mfma_f32_16x16x32_bf16 v[40:43], v[72:75], v[80:83], v[40:43]
    ds_read_b128 v[152:155], v12 offset:36864
    v_mfma_f32_16x16x32_bf16 v[44:47], v[76:79], v[80:83], v[44:47]
    ds_read_b128 v[156:159], v12 offset:38912
    v_mfma_f32_16x16x32_bf16 v[32:35], v[84:87], v[100:103], v[32:35]
    ds_read_b128 v[180:183], v14 offset:33792
    ds_read_b128 v[164:167], v13 offset:32768
    v_mfma_f32_16x16x32_bf16 v[36:39], v[88:91], v[100:103], v[36:39]
    ds_read_b128 v[168:171], v13 offset:34816
    v_mfma_f32_16x16x32_bf16 v[40:43], v[92:95], v[100:103], v[40:43]
    ds_read_b128 v[172:175], v13 offset:36864
    v_mfma_f32_16x16x32_bf16 v[44:47], v[96:99], v[100:103], v[44:47]
    ds_read_b128 v[176:179], v13 offset:38912
    v_mfma_f32_16x16x32_bf16 v[32:35], v[104:107], v[120:123], v[32:35]
    ds_read_b128 v[200:203], v14 offset:34816
    ds_read_b128 v[184:187], v12 offset:40960
    v_mfma_f32_16x16x32_bf16 v[36:39], v[108:111], v[120:123], v[36:39]
    ds_read_b128 v[188:191], v12 offset:43008
    v_mfma_f32_16x16x32_bf16 v[40:43], v[112:115], v[120:123], v[40:43]
    ds_read_b128 v[192:195], v12 offset:45056
    v_mfma_f32_16x16x32_bf16 v[44:47], v[116:119], v[120:123], v[44:47]
    ds_read_b128 v[196:199], v12 offset:47104
    v_mfma_f32_16x16x32_bf16 v[32:35], v[124:127], v[140:143], v[32:35]
    ds_read_b128 v[220:223], v14 offset:35840
    ds_read_b128 v[204:207], v13 offset:40960
    v_mfma_f32_16x16x32_bf16 v[36:39], v[128:131], v[140:143], v[36:39]
    ds_read_b128 v[208:211], v13 offset:43008
    v_mfma_f32_16x16x32_bf16 v[40:43], v[132:135], v[140:143], v[40:43]
    ds_read_b128 v[212:215], v13 offset:45056
    v_mfma_f32_16x16x32_bf16 v[44:47], v[136:139], v[140:143], v[44:47]
    ds_read_b128 v[216:219], v13 offset:47104
    s_waitcnt lgkmcnt(0)
    v_mfma_f32_16x16x32_bf16 v[32:35], v[144:147], v[160:163], v[32:35]
    v_mfma_f32_16x16x32_bf16 v[36:39], v[148:151], v[160:163], v[36:39]
    v_mfma_f32_16x16x32_bf16 v[40:43], v[152:155], v[160:163], v[40:43]
    v_mfma_f32_16x16x32_bf16 v[44:47], v[156:159], v[160:163], v[44:47]
    v_mfma_f32_16x16x32_bf16 v[32:35], v[164:167], v[180:183], v[32:35]
    v_mfma_f32_16x16x32_bf16 v[36:39], v[168:171], v[180:183], v[36:39]
    v_mfma_f32_16x16x32_bf16 v[40:43], v[172:175], v[180:183], v[40:43]
    v_mfma_f32_16x16x32_bf16 v[44:47], v[176:179], v[180:183], v[44:47]
    v_mfma_f32_16x16x32_bf16 v[32:35], v[184:187], v[200:203], v[32:35]
    v_mfma_f32_16x16x32_bf16 v[36:39], v[188:191], v[200:203], v[36:39]
    v_mfma_f32_16x16x32_bf16 v[40:43], v[192:195], v[200:203], v[40:43]
    v_mfma_f32_16x16x32_bf16 v[44:47], v[196:199], v[200:203], v[44:47]
    v_mfma_f32_16x16x32_bf16 v[32:35], v[204:207], v[220:223], v[32:35]
    v_mfma_f32_16x16x32_bf16 v[36:39], v[208:211], v[220:223], v[36:39]
    v_mfma_f32_16x16x32_bf16 v[40:43], v[212:215], v[220:223], v[40:43]
    v_mfma_f32_16x16x32_bf16 v[44:47], v[216:219], v[220:223], v[44:47]
    s_waitcnt vmcnt(0)
    s_nop 3
    v_cndmask_b32 v20, v32, v34, s[28:29]
    v_cndmask_b32 v21, v33, v35, s[28:29]
    s_nop 0
    v_mov_b32_dpp v22, v20 row_ror:8 row_mask:0xf bank_mask:0xf
    v_mov_b32_dpp v23, v21 row_ror:8 row_mask:0xf bank_mask:0xf
    v_cndmask_b32 v64, v22, v32, s[28:29]
    v_cndmask_b32 v65, v34, v22, s[28:29]
    v_cndmask_b32 v66, v23, v33, s[28:29]
    v_cndmask_b32 v67, v35, v23, s[28:29]
    v_cndmask_b32 v20, v36, v38, s[28:29]
    v_cndmask_b32 v21, v37, v39, s[28:29]
    s_nop 0
    v_mov_b32_dpp v22, v20 row_ror:8 row_mask:0xf bank_mask:0xf
    v_mov_b32_dpp v23, v21 row_ror:8 row_mask:0xf bank_mask:0xf
    v_cndmask_b32 v68, v22, v36, s[28:29]
    v_cndmask_b32 v69, v38, v22, s[28:29]
    v_cndmask_b32 v70, v23, v37, s[28:29]
    v_cndmask_b32 v71, v39, v23, s[28:29]
    v_cndmask_b32 v20, v40, v42, s[28:29]
    v_cndmask_b32 v21, v41, v43, s[28:29]
    s_nop 0
    v_mov_b32_dpp v22, v20 row_ror:8 row_mask:0xf bank_mask:0xf
    v_mov_b32_dpp v23, v21 row_ror:8 row_mask:0xf bank_mask:0xf
    v_cndmask_b32 v72, v22, v40, s[28:29]
    v_cndmask_b32 v73, v42, v22, s[28:29]
    v_cndmask_b32 v74, v23, v41, s[28:29]
    v_cndmask_b32 v75, v43, v23, s[28:29]
    v_cndmask_b32 v20, v44, v46, s[28:29]
    v_cndmask_b32 v21, v45, v47, s[28:29]
    s_nop 0
    v_mov_b32_dpp v22, v20 row_ror:8 row_mask:0xf bank_mask:0xf
    v_mov_b32_dpp v23, v21 row_ror:8 row_mask:0xf bank_mask:0xf
    v_cndmask_b32 v76, v22, v44, s[28:29]
    v_cndmask_b32 v77, v46, v22, s[28:29]
    v_cndmask_b32 v78, v23, v45, s[28:29]
    v_cndmask_b32 v79, v47, v23, s[28:29]
    v_lshlrev_b32 v80, 16, v224
    v_and_b32 v81, 0xffff0000, v224
    v_lshlrev_b32 v104, 16, v232
    v_and_b32 v105, 0xffff0000, v232
    v_lshlrev_b32 v82, 16, v225
    v_and_b32 v83, 0xffff0000, v225
    v_lshlrev_b32 v106, 16, v233
    v_and_b32 v107, 0xffff0000, v233
    v_lshlrev_b32 v84, 16, v226
    v_and_b32 v85, 0xffff0000, v226
    v_lshlrev_b32 v108, 16, v234
    v_and_b32 v109, 0xffff0000, v234
    v_lshlrev_b32 v86, 16, v227
    v_and_b32 v87, 0xffff0000, v227
    v_lshlrev_b32 v110, 16, v235
    v_and_b32 v111, 0xffff0000, v235
    v_lshlrev_b32 v88, 16, v228
    v_and_b32 v89, 0xffff0000, v228
    v_lshlrev_b32 v112, 16, v236
    v_and_b32 v113, 0xffff0000, v236
    v_lshlrev_b32 v90, 16, v229
    v_and_b32 v91, 0xffff0000, v229
    v_lshlrev_b32 v114, 16, v237
    v_and_b32 v115, 0xffff0000, v237
    v_lshlrev_b32 v92, 16, v230
    v_and_b32 v93, 0xffff0000, v230
    v_lshlrev_b32 v116, 16, v238
    v_and_b32 v117, 0xffff0000, v238
    v_lshlrev_b32 v94, 16, v231
    v_and_b32 v95, 0xffff0000, v231
    v_lshlrev_b32 v118, 16, v239
    v_and_b32 v119, 0xffff0000, v239
    v_pk_add_f32 v[64:65], v[64:65], v[80:81]
    v_pk_add_f32 v[66:67], v[66:67], v[82:83]
    v_pk_add_f32 v[68:69], v[68:69], v[84:85]
    v_pk_add_f32 v[70:71], v[70:71], v[86:87]
    v_pk_add_f32 v[72:73], v[72:73], v[88:89]
    v_pk_add_f32 v[74:75], v[74:75], v[90:91]
    v_pk_add_f32 v[76:77], v[76:77], v[92:93]
    v_pk_add_f32 v[78:79], v[78:79], v[94:95]
    v_pk_fma_f32 v[64:65], v[64:65], v[240:241], v[104:105]
    v_pk_fma_f32 v[66:67], v[66:67], v[240:241], v[106:107]
    v_pk_fma_f32 v[68:69], v[68:69], v[240:241], v[108:109]
    v_pk_fma_f32 v[70:71], v[70:71], v[240:241], v[110:111]
    v_pk_fma_f32 v[72:73], v[72:73], v[240:241], v[112:113]
    v_pk_fma_f32 v[74:75], v[74:75], v[240:241], v[114:115]
    v_pk_fma_f32 v[76:77], v[76:77], v[240:241], v[116:117]
    v_pk_fma_f32 v[78:79], v[78:79], v[240:241], v[118:119]
    v_cvt_pk_bf16_f32 v96, v64, v65
    global_store_dword v7, v96, s[4:5] offset:0
    v_cvt_pk_bf16_f32 v97, v66, v67
    global_store_dword v7, v97, s[4:5] offset:896
    v_cvt_pk_bf16_f32 v98, v68, v69
    v_add_u32 v7, 14336, v7
    global_store_dword v7, v98, s[4:5] offset:0
    v_cvt_pk_bf16_f32 v99, v70, v71
    global_store_dword v7, v99, s[4:5] offset:896
    v_cvt_pk_bf16_f32 v100, v72, v73
    v_add_u32 v7, 14336, v7
    global_store_dword v7, v100, s[4:5] offset:0
    v_cvt_pk_bf16_f32 v101, v74, v75
    global_store_dword v7, v101, s[4:5] offset:896
    v_cvt_pk_bf16_f32 v102, v76, v77
    v_add_u32 v7, 14336, v7
    global_store_dword v7, v102, s[4:5] offset:0
    v_cvt_pk_bf16_f32 v103, v78, v79
    global_store_dword v7, v103, s[4:5] offset:896
K6_END:
    s_endpgm
.section .rodata,"a"
.p2align 6
.amdhsa_kernel prep_kernel
  .amdhsa_next_free_vgpr 128
  .amdhsa_next_free_sgpr 32
  .amdhsa_accum_offset 128
  .amdhsa_group_segment_fixed_size 0
  .amdhsa_kernarg_size 152
  .amdhsa_user_sgpr_count 2
  .amdhsa_user_sgpr_kernarg_segment_ptr 1
  .amdhsa_system_sgpr_workgroup_id_x 1
.end_amdhsa_kernel
.p2align 6
.amdhsa_kernel conv_kernel
  .amdhsa_next_free_vgpr 256
  .amdhsa_next_free_sgpr 40
  .amdhsa_accum_offset 256
  .amdhsa_group_segment_fixed_size 0
  .amdhsa_kernarg_size 152
  .amdhsa_user_sgpr_count 2
  .amdhsa_user_sgpr_kernarg_segment_ptr 1
  .amdhsa_system_sgpr_workgroup_id_x 1
.end_amdhsa_kernel
.p2align 6
.amdhsa_kernel ln_gemm1_kernel
  .amdhsa_next_free_vgpr 168
  .amdhsa_next_free_sgpr 48
  .amdhsa_accum_offset 168
  .amdhsa_group_segment_fixed_size 0
  .amdhsa_kernarg_size 152
  .amdhsa_user_sgpr_count 2
  .amdhsa_user_sgpr_kernarg_segment_ptr 1
  .amdhsa_system_sgpr_workgroup_id_x 1
.end_amdhsa_kernel
.p2align 6
.amdhsa_kernel gemm2_kernel
  .amdhsa_next_free_vgpr 220
  .amdhsa_next_free_sgpr 40
  .amdhsa_accum_offset 220
  .amdhsa_group_segment_fixed_size 0
  .amdhsa_kernarg_size 152
  .amdhsa_user_sgpr_count 2
  .amdhsa_user_sgpr_kernarg_segment_ptr 1
  .amdhsa_system_sgpr_workgroup_id_x 1
.end_amdhsa_kernel
.p2align 6
.amdhsa_kernel gemm3_kernel
  .amdhsa_next_free_vgpr 248
  .amdhsa_next_free_sgpr 40
  .amdhsa_accum_offset 248
  .amdhsa_group_segment_fixed_size 0
  .amdhsa_kernarg_size 152
  .amdhsa_user_sgpr_count 2
  .amdhsa_user_sgpr_kernarg_segment_ptr 1
  .amdhsa_system_sgpr_workgroup_id_x 1
.end_amdhsa_kernel
.p2align 6
.amdhsa_kernel gemm4_kernel
  .amdhsa_next_free_vgpr 244
  .amdhsa_next_free_sgpr 40
  .amdhsa_accum_offset 244
  .amdhsa_group_segment_fixed_size 0
  .amdhsa_kernarg_size 152
  .amdhsa_user_sgpr_count 2
  .amdhsa_user_sgpr_kernarg_segment_ptr 1
  .amdhsa_system_sgpr_workgroup_id_x 1
.end_amdhsa_kernel
```
